```python
import torch

def _softmax(x, axis=-1):
    return torch.softmax(x, dim=axis)
def _gelu(x):
    return torch.nn.functional.gelu(x, approximate="tanh")
def _silu(x):
    return torch.nn.functional.silu(x)
def _sigmoid(x):
    return torch.sigmoid(x)
def _layernorm(x, axis=-1, eps=1e-5):
    m = x.mean(dim=axis, keepdim=True)
    v = x.var(dim=axis, keepdim=True, unbiased=False)
    return (x - m) / torch.sqrt(v + eps)
def _scatter_add(tgt, idx, src, axis=0):
    return tgt.clone().index_add_(axis, idx, src)
def _segment_sum(src, seg, n):
    out = torch.zeros((n,) + src.shape[1:], dtype=src.dtype)
    return out.index_add_(0, seg, src)
def _pad(x, pw):
    flat = tuple(v for pair in reversed(pw) for v in pair)
    return torch.nn.functional.pad(x, flat)

kernel_name = 'concat_heads__gqa_block_cached__sliding_block_cached__decode'

def setup_inputs():

    _w = (lambda a: (lambda t: t.to(torch.bfloat16) if t.is_floating_point() else t)(torch.as_tensor(a)))
    def _A_setup():
        B, Sq, D = 1, 1, 640
        Hq, Hkv, Sk, Dh = 32, 32, 8192, 128
        assert Hq % Hkv == 0, (Hq, Hkv)
        return {
            "x": _w((lambda *s: torch.randn(*s, dtype=torch.bfloat16) * 0.8)(B, Sq, D)),
            "k_cache": _w((lambda *s: torch.randn(*s, dtype=torch.bfloat16) * 1.6)(B, Hkv, Sk, Dh)),
            "v_cache": _w((lambda *s: torch.randn(*s, dtype=torch.bfloat16) * 0.2)(B, Hkv, Sk, Dh)),
            "wq": _w((lambda *s: torch.randn(*s, dtype=torch.bfloat16) * 1.6)(D, Hq * Dh) * (D ** -0.5)),
            "wo": _w((lambda *s: torch.randn(*s, dtype=torch.bfloat16) * 0.2)(Hq * Dh, D) * ((Hq * Dh) ** -0.5)),
        }
    _A_in = _A_setup()

    def _B_setup():
        B, Sq, D = 1, 1, 640
        Hq, Hkv, Sk, Dh = 32, 32, 8192, 128
        assert Hq % Hkv == 0, (Hq, Hkv)
        return {
            "x": _w((lambda *s: torch.randn(*s, dtype=torch.bfloat16) * 0.8)(B, Sq, D)),
            "k_cache": _w((lambda *s: torch.randn(*s, dtype=torch.bfloat16) * 1.6)(B, Hkv, Sk, Dh)),
            "v_cache": _w((lambda *s: torch.randn(*s, dtype=torch.bfloat16) * 0.2)(B, Hkv, Sk, Dh)),
            "wq": _w((lambda *s: torch.randn(*s, dtype=torch.bfloat16) * 1.6)(D, Hq * Dh) * (D ** -0.5)),
            "wo": _w((lambda *s: torch.randn(*s, dtype=torch.bfloat16) * 0.2)(Hq * Dh, D) * ((Hq * Dh) ** -0.5)),
        }
    _B_in = _B_setup()

    return {
        "A_x": _A_in["x"],
        "A_k_cache": _A_in["k_cache"],
        "A_v_cache": _A_in["v_cache"],
        "A_wq": _A_in["wq"],
        "A_wo": _A_in["wo"],
        "B_x": _B_in["x"],
        "B_k_cache": _B_in["k_cache"],
        "B_v_cache": _B_in["v_cache"],
        "B_wq": _B_in["wq"],
        "B_wo": _B_in["wo"],
    }

def reference(A_x, A_k_cache, A_v_cache, A_wq, A_wo, B_x, B_k_cache, B_v_cache, B_wq, B_wo):
    def _A_ref(x, k_cache, v_cache, wq, wo):
        B, Sq, D = x.shape
        Hq, Dh = 32, 128
        Hkv = k_cache.shape[1]
        rep = Hq // Hkv
        q = (lambda x, *d: x.permute(*d))((x @ wq).reshape(B, Sq, Hq, Dh), 0, 2, 1, 3)
        k = (lambda x, n, axis: torch.repeat_interleave(x, n, dim=axis))(k_cache, rep, axis=1)
        v = (lambda x, n, axis: torch.repeat_interleave(x, n, dim=axis))(v_cache, rep, axis=1)
        scores = torch.einsum("bhqd,bhkd->bhqk", q, k) * (Dh ** -0.5)
        p = _softmax(scores, axis=-1)
        o = torch.einsum("bhqk,bhkd->bhqd", p, v)
        return (lambda x, *d: x.permute(*d))(o, 0, 2, 1, 3).reshape(B, Sq, Hq * Dh) @ wo

    def _B_ref(x, k_cache, v_cache, wq, wo):
        B, Sq, D = x.shape
        Hq, Dh = 32, 128
        Hkv, Sk = k_cache.shape[1], k_cache.shape[2]
        W = min(4096, max(256, Sk // 4))
        rep = Hq // Hkv
        q = (lambda x, *d: x.permute(*d))((x @ wq).reshape(B, Sq, Hq, Dh), 0, 2, 1, 3)
        k = (lambda x, n, axis: torch.repeat_interleave(x, n, dim=axis))(k_cache[:, :, Sk - W:, :], rep, axis=1)
        v = (lambda x, n, axis: torch.repeat_interleave(x, n, dim=axis))(v_cache[:, :, Sk - W:, :], rep, axis=1)
        scores = torch.einsum("bhqd,bhkd->bhqk", q, k) * (Dh ** -0.5)
        p = _softmax(scores, axis=-1)
        o = torch.einsum("bhqk,bhkd->bhqd", p, v)
        return (lambda x, *d: x.permute(*d))(o, 0, 2, 1, 3).reshape(B, Sq, Hq * Dh) @ wo

    a = _A_ref(A_x, A_k_cache, A_v_cache, A_wq, A_wo)
    b = _B_ref(B_x, B_k_cache, B_v_cache, B_wq, B_wo)
    return torch.concatenate([a, b], axis=-1)
```

```asm
; @launch kernel=qproj_kernel grid=(256,1,1) block=(256,1,1) lds=8192
; @launch kernel=attn_kernel grid=(1280,1,1) block=(256,1,1) lds=8448
; @launch kernel=oproj_kernel grid=(320,1,1) block=(256,1,1) lds=9216
.amdgcn_target "amdgcn-amd-amdhsa--gfx950"
.text
.globl qproj_kernel
.p2align 8
.type qproj_kernel,@function
qproj_kernel:
    s_cmp_ge_u32 s2, 256
    s_cbranch_scc1 L_q_done
    s_lshr_b32 s3, s2, 7
    s_mul_i32 s4, s3, 40
    s_add_u32 s6, s0, s4
    s_addc_u32 s7, s1, 0
    s_load_dwordx2 s[8:9], s[6:7], 0
    s_load_dwordx2 s[12:13], s[6:7], 24
    s_load_dwordx2 s[16:17], s[0:1], 96
    s_and_b32 s20, s2, 127
    s_lshr_b32 s21, s20, 1
    s_and_b32 s22, s2, 1
    v_and_b32 v1, 7, v0
    v_lshrrev_b32 v2, 3, v0
    s_mul_i32 s23, s22, 320
    v_add_u32 v3, s23, v2
    v_lshlrev_b32 v4, 13, v3
    v_lshlrev_b32 v5, 4, v1
    v_add_u32 v4, v4, v5
    s_lshl_b32 s24, s21, 7
    v_add_u32 v4, s24, v4
    v_lshlrev_b32 v5, 1, v3
    s_waitcnt lgkmcnt(0)
    s_mov_b32 s10, 1280
    s_mov_b32 s11, 0x00020000
    s_mov_b32 s14, 5242880
    s_mov_b32 s15, 0x00020000
    s_mov_b32 s18, 289409536
    s_mov_b32 s19, 0x00020000
    s_mov_b32 s30, 0
    s_mov_b32 s31, 262144
    s_mov_b32 s32, 524288
    s_mov_b32 s33, 786432
    s_mov_b32 s34, 1048576
    s_mov_b32 s35, 1310720
    s_mov_b32 s36, 1572864
    s_mov_b32 s37, 1835008
    s_mov_b32 s38, 2097152
    s_mov_b32 s39, 2359296
    buffer_load_dwordx4 v[16:19], v4, s[12:15], s30 offen nt
    buffer_load_dwordx4 v[20:23], v4, s[12:15], s31 offen nt
    buffer_load_dwordx4 v[24:27], v4, s[12:15], s32 offen nt
    buffer_load_dwordx4 v[28:31], v4, s[12:15], s33 offen nt
    buffer_load_dwordx4 v[32:35], v4, s[12:15], s34 offen nt
    buffer_load_dwordx4 v[36:39], v4, s[12:15], s35 offen nt
    buffer_load_dwordx4 v[40:43], v4, s[12:15], s36 offen nt
    buffer_load_dwordx4 v[44:47], v4, s[12:15], s37 offen nt
    buffer_load_dwordx4 v[48:51], v4, s[12:15], s38 offen nt
    buffer_load_dwordx4 v[52:55], v4, s[12:15], s39 offen nt
    buffer_load_ushort v60, v5, s[8:11], 0 offen offset:0
    buffer_load_ushort v61, v5, s[8:11], 0 offen offset:64
    buffer_load_ushort v62, v5, s[8:11], 0 offen offset:128
    buffer_load_ushort v63, v5, s[8:11], 0 offen offset:192
    buffer_load_ushort v64, v5, s[8:11], 0 offen offset:256
    buffer_load_ushort v65, v5, s[8:11], 0 offen offset:320
    buffer_load_ushort v66, v5, s[8:11], 0 offen offset:384
    buffer_load_ushort v67, v5, s[8:11], 0 offen offset:448
    buffer_load_ushort v68, v5, s[8:11], 0 offen offset:512
    buffer_load_ushort v69, v5, s[8:11], 0 offen offset:576
    v_mov_b32 v8, 0
    v_mov_b32 v9, 0
    v_mov_b32 v10, 0
    v_mov_b32 v11, 0
    v_mov_b32 v12, 0
    v_mov_b32 v13, 0
    v_mov_b32 v14, 0
    v_mov_b32 v15, 0
    s_waitcnt vmcnt(9)
    v_lshlrev_b32 v70, 16, v60
    v_lshlrev_b32 v71, 16, v16
    v_and_b32 v72, 0xffff0000, v16
    v_fmac_f32 v8, v71, v70
    v_fmac_f32 v9, v72, v70
    v_lshlrev_b32 v71, 16, v17
    v_and_b32 v72, 0xffff0000, v17
    v_fmac_f32 v10, v71, v70
    v_fmac_f32 v11, v72, v70
    v_lshlrev_b32 v71, 16, v18
    v_and_b32 v72, 0xffff0000, v18
    v_fmac_f32 v12, v71, v70
    v_fmac_f32 v13, v72, v70
    v_lshlrev_b32 v71, 16, v19
    v_and_b32 v72, 0xffff0000, v19
    v_fmac_f32 v14, v71, v70
    v_fmac_f32 v15, v72, v70
    s_waitcnt vmcnt(8)
    v_lshlrev_b32 v70, 16, v61
    v_lshlrev_b32 v71, 16, v20
    v_and_b32 v72, 0xffff0000, v20
    v_fmac_f32 v8, v71, v70
    v_fmac_f32 v9, v72, v70
    v_lshlrev_b32 v71, 16, v21
    v_and_b32 v72, 0xffff0000, v21
    v_fmac_f32 v10, v71, v70
    v_fmac_f32 v11, v72, v70
    v_lshlrev_b32 v71, 16, v22
    v_and_b32 v72, 0xffff0000, v22
    v_fmac_f32 v12, v71, v70
    v_fmac_f32 v13, v72, v70
    v_lshlrev_b32 v71, 16, v23
    v_and_b32 v72, 0xffff0000, v23
    v_fmac_f32 v14, v71, v70
    v_fmac_f32 v15, v72, v70
    s_waitcnt vmcnt(7)
    v_lshlrev_b32 v70, 16, v62
    v_lshlrev_b32 v71, 16, v24
    v_and_b32 v72, 0xffff0000, v24
    v_fmac_f32 v8, v71, v70
    v_fmac_f32 v9, v72, v70
    v_lshlrev_b32 v71, 16, v25
    v_and_b32 v72, 0xffff0000, v25
    v_fmac_f32 v10, v71, v70
    v_fmac_f32 v11, v72, v70
    v_lshlrev_b32 v71, 16, v26
    v_and_b32 v72, 0xffff0000, v26
    v_fmac_f32 v12, v71, v70
    v_fmac_f32 v13, v72, v70
    v_lshlrev_b32 v71, 16, v27
    v_and_b32 v72, 0xffff0000, v27
    v_fmac_f32 v14, v71, v70
    v_fmac_f32 v15, v72, v70
    s_waitcnt vmcnt(6)
    v_lshlrev_b32 v70, 16, v63
    v_lshlrev_b32 v71, 16, v28
    v_and_b32 v72, 0xffff0000, v28
    v_fmac_f32 v8, v71, v70
    v_fmac_f32 v9, v72, v70
    v_lshlrev_b32 v71, 16, v29
    v_and_b32 v72, 0xffff0000, v29
    v_fmac_f32 v10, v71, v70
    v_fmac_f32 v11, v72, v70
    v_lshlrev_b32 v71, 16, v30
    v_and_b32 v72, 0xffff0000, v30
    v_fmac_f32 v12, v71, v70
    v_fmac_f32 v13, v72, v70
    v_lshlrev_b32 v71, 16, v31
    v_and_b32 v72, 0xffff0000, v31
    v_fmac_f32 v14, v71, v70
    v_fmac_f32 v15, v72, v70
    s_waitcnt vmcnt(5)
    v_lshlrev_b32 v70, 16, v64
    v_lshlrev_b32 v71, 16, v32
    v_and_b32 v72, 0xffff0000, v32
    v_fmac_f32 v8, v71, v70
    v_fmac_f32 v9, v72, v70
    v_lshlrev_b32 v71, 16, v33
    v_and_b32 v72, 0xffff0000, v33
    v_fmac_f32 v10, v71, v70
    v_fmac_f32 v11, v72, v70
    v_lshlrev_b32 v71, 16, v34
    v_and_b32 v72, 0xffff0000, v34
    v_fmac_f32 v12, v71, v70
    v_fmac_f32 v13, v72, v70
    v_lshlrev_b32 v71, 16, v35
    v_and_b32 v72, 0xffff0000, v35
    v_fmac_f32 v14, v71, v70
    v_fmac_f32 v15, v72, v70
    s_waitcnt vmcnt(4)
    v_lshlrev_b32 v70, 16, v65
    v_lshlrev_b32 v71, 16, v36
    v_and_b32 v72, 0xffff0000, v36
    v_fmac_f32 v8, v71, v70
    v_fmac_f32 v9, v72, v70
    v_lshlrev_b32 v71, 16, v37
    v_and_b32 v72, 0xffff0000, v37
    v_fmac_f32 v10, v71, v70
    v_fmac_f32 v11, v72, v70
    v_lshlrev_b32 v71, 16, v38
    v_and_b32 v72, 0xffff0000, v38
    v_fmac_f32 v12, v71, v70
    v_fmac_f32 v13, v72, v70
    v_lshlrev_b32 v71, 16, v39
    v_and_b32 v72, 0xffff0000, v39
    v_fmac_f32 v14, v71, v70
    v_fmac_f32 v15, v72, v70
    s_waitcnt vmcnt(3)
    v_lshlrev_b32 v70, 16, v66
    v_lshlrev_b32 v71, 16, v40
    v_and_b32 v72, 0xffff0000, v40
    v_fmac_f32 v8, v71, v70
    v_fmac_f32 v9, v72, v70
    v_lshlrev_b32 v71, 16, v41
    v_and_b32 v72, 0xffff0000, v41
    v_fmac_f32 v10, v71, v70
    v_fmac_f32 v11, v72, v70
    v_lshlrev_b32 v71, 16, v42
    v_and_b32 v72, 0xffff0000, v42
    v_fmac_f32 v12, v71, v70
    v_fmac_f32 v13, v72, v70
    v_lshlrev_b32 v71, 16, v43
    v_and_b32 v72, 0xffff0000, v43
    v_fmac_f32 v14, v71, v70
    v_fmac_f32 v15, v72, v70
    s_waitcnt vmcnt(2)
    v_lshlrev_b32 v70, 16, v67
    v_lshlrev_b32 v71, 16, v44
    v_and_b32 v72, 0xffff0000, v44
    v_fmac_f32 v8, v71, v70
    v_fmac_f32 v9, v72, v70
    v_lshlrev_b32 v71, 16, v45
    v_and_b32 v72, 0xffff0000, v45
    v_fmac_f32 v10, v71, v70
    v_fmac_f32 v11, v72, v70
    v_lshlrev_b32 v71, 16, v46
    v_and_b32 v72, 0xffff0000, v46
    v_fmac_f32 v12, v71, v70
    v_fmac_f32 v13, v72, v70
    v_lshlrev_b32 v71, 16, v47
    v_and_b32 v72, 0xffff0000, v47
    v_fmac_f32 v14, v71, v70
    v_fmac_f32 v15, v72, v70
    s_waitcnt vmcnt(1)
    v_lshlrev_b32 v70, 16, v68
    v_lshlrev_b32 v71, 16, v48
    v_and_b32 v72, 0xffff0000, v48
    v_fmac_f32 v8, v71, v70
    v_fmac_f32 v9, v72, v70
    v_lshlrev_b32 v71, 16, v49
    v_and_b32 v72, 0xffff0000, v49
    v_fmac_f32 v10, v71, v70
    v_fmac_f32 v11, v72, v70
    v_lshlrev_b32 v71, 16, v50
    v_and_b32 v72, 0xffff0000, v50
    v_fmac_f32 v12, v71, v70
    v_fmac_f32 v13, v72, v70
    v_lshlrev_b32 v71, 16, v51
    v_and_b32 v72, 0xffff0000, v51
    v_fmac_f32 v14, v71, v70
    v_fmac_f32 v15, v72, v70
    s_waitcnt vmcnt(0)
    v_lshlrev_b32 v70, 16, v69
    v_lshlrev_b32 v71, 16, v52
    v_and_b32 v72, 0xffff0000, v52
    v_fmac_f32 v8, v71, v70
    v_fmac_f32 v9, v72, v70
    v_lshlrev_b32 v71, 16, v53
    v_and_b32 v72, 0xffff0000, v53
    v_fmac_f32 v10, v71, v70
    v_fmac_f32 v11, v72, v70
    v_lshlrev_b32 v71, 16, v54
    v_and_b32 v72, 0xffff0000, v54
    v_fmac_f32 v12, v71, v70
    v_fmac_f32 v13, v72, v70
    v_lshlrev_b32 v71, 16, v55
    v_and_b32 v72, 0xffff0000, v55
    v_fmac_f32 v14, v71, v70
    v_fmac_f32 v15, v72, v70
    v_lshlrev_b32 v6, 8, v2
    v_lshlrev_b32 v7, 5, v1
    v_add_u32 v6, v6, v7
    ds_write_b128 v6, v[8:11]
    ds_write_b128 v6, v[12:15] offset:16
    s_waitcnt lgkmcnt(0)
    s_barrier
    v_cmp_gt_u32 vcc, 64, v0
    s_and_saveexec_b64 s[26:27], vcc
    s_cbranch_execz L_q_done
    v_lshlrev_b32 v6, 2, v0
    ds_read_b32 v16, v6 offset:0
    ds_read_b32 v17, v6 offset:256
    ds_read_b32 v18, v6 offset:512
    ds_read_b32 v19, v6 offset:768
    ds_read_b32 v20, v6 offset:1024
    ds_read_b32 v21, v6 offset:1280
    ds_read_b32 v22, v6 offset:1536
    ds_read_b32 v23, v6 offset:1792
    ds_read_b32 v24, v6 offset:2048
    ds_read_b32 v25, v6 offset:2304
    ds_read_b32 v26, v6 offset:2560
    ds_read_b32 v27, v6 offset:2816
    ds_read_b32 v28, v6 offset:3072
    ds_read_b32 v29, v6 offset:3328
    ds_read_b32 v30, v6 offset:3584
    ds_read_b32 v31, v6 offset:3840
    ds_read_b32 v32, v6 offset:4096
    ds_read_b32 v33, v6 offset:4352
    ds_read_b32 v34, v6 offset:4608
    ds_read_b32 v35, v6 offset:4864
    ds_read_b32 v36, v6 offset:5120
    ds_read_b32 v37, v6 offset:5376
    ds_read_b32 v38, v6 offset:5632
    ds_read_b32 v39, v6 offset:5888
    ds_read_b32 v40, v6 offset:6144
    ds_read_b32 v41, v6 offset:6400
    ds_read_b32 v42, v6 offset:6656
    ds_read_b32 v43, v6 offset:6912
    ds_read_b32 v44, v6 offset:7168
    ds_read_b32 v45, v6 offset:7424
    ds_read_b32 v46, v6 offset:7680
    ds_read_b32 v47, v6 offset:7936
    s_waitcnt lgkmcnt(0)
    v_add_f32 v16, v16, v17
    v_add_f32 v16, v16, v18
    v_add_f32 v16, v16, v19
    v_add_f32 v16, v16, v20
    v_add_f32 v16, v16, v21
    v_add_f32 v16, v16, v22
    v_add_f32 v16, v16, v23
    v_add_f32 v16, v16, v24
    v_add_f32 v16, v16, v25
    v_add_f32 v16, v16, v26
    v_add_f32 v16, v16, v27
    v_add_f32 v16, v16, v28
    v_add_f32 v16, v16, v29
    v_add_f32 v16, v16, v30
    v_add_f32 v16, v16, v31
    v_add_f32 v16, v16, v32
    v_add_f32 v16, v16, v33
    v_add_f32 v16, v16, v34
    v_add_f32 v16, v16, v35
    v_add_f32 v16, v16, v36
    v_add_f32 v16, v16, v37
    v_add_f32 v16, v16, v38
    v_add_f32 v16, v16, v39
    v_add_f32 v16, v16, v40
    v_add_f32 v16, v16, v41
    v_add_f32 v16, v16, v42
    v_add_f32 v16, v16, v43
    v_add_f32 v16, v16, v44
    v_add_f32 v16, v16, v45
    v_add_f32 v16, v16, v46
    v_add_f32 v16, v16, v47
    s_lshl_b32 s25, s3, 1
    s_add_u32 s25, s25, s22
    s_lshl_b32 s25, s25, 14
    s_lshl_b32 s28, s21, 8
    s_add_u32 s25, s25, s28
    v_add_u32 v6, s25, v6
    buffer_store_dword v16, v6, s[16:19], 0 offen
L_q_done:
    s_endpgm
.globl attn_kernel
.p2align 8
.type attn_kernel,@function
attn_kernel:
    s_cmp_ge_u32 s2, 1280
    s_cbranch_scc1 L_a_done
    s_cmp_ge_u32 s2, 1024
    s_cselect_b32 s3, 1, 0
    s_mul_i32 s4, s3, 40
    s_add_u32 s6, s0, s4
    s_addc_u32 s7, s1, 0
    s_load_dwordx4 s[8:11], s[6:7], 8
    s_load_dwordx2 s[16:17], s[0:1], 96
    s_lshr_b32 s20, s2, 5
    s_and_b32 s21, s2, 31
    s_lshl_b32 s21, s21, 8
    s_sub_u32 s22, s2, 1024
    s_lshr_b32 s23, s22, 3
    s_and_b32 s24, s22, 7
    s_lshl_b32 s24, s24, 8
    s_add_u32 s24, s24, 6144
    s_cmp_eq_u32 s3, 1
    s_cselect_b32 s20, s23, s20
    s_cselect_b32 s21, s24, s21
    v_and_b32 v1, 63, v0
    v_lshrrev_b32 v2, 6, v0
    s_lshl_b32 s25, s20, 21
    s_lshl_b32 s26, s21, 8
    s_add_u32 s25, s25, s26
    v_lshlrev_b32 v3, 4, v1
    v_lshlrev_b32 v4, 14, v2
    v_add_u32 v3, v3, v4
    v_add_u32 v3, s25, v3
    v_and_b32 v5, 15, v1
    v_lshlrev_b32 v5, 5, v5
    s_lshl_b32 s27, s3, 15
    s_lshl_b32 s28, s20, 9
    s_add_u32 s27, s27, s28
    v_add_u32 v5, s27, v5
    s_waitcnt lgkmcnt(0)
    s_mov_b32 s12, s10
    s_mov_b32 s13, s11
    s_mov_b32 s14, 67108864
    s_mov_b32 s15, 0x00020000
    s_mov_b32 s10, 67108864
    s_mov_b32 s11, 0x00020000
    s_mov_b32 s18, 289409536
    s_mov_b32 s19, 0x00020000
    buffer_load_dwordx4 v[8:11], v5, s[16:19], 0 offen
    buffer_load_dwordx4 v[12:15], v5, s[16:19], 0 offen offset:16
    s_movk_i32 s29, 0x4000
    buffer_load_dwordx4 v[16:19], v5, s[16:19], s29 offen
    buffer_load_dwordx4 v[20:23], v5, s[16:19], s29 offen offset:16
    buffer_load_dwordx4 v[32:35], v3, s[8:11], 0 offen offset:0 nt
    s_movk_i32 s31, 4096
    s_movk_i32 s32, 8192
    s_movk_i32 s33, 12288
    buffer_load_dwordx4 v[36:39], v3, s[8:11], 0 offen offset:1024 nt
    buffer_load_dwordx4 v[40:43], v3, s[8:11], 0 offen offset:2048 nt
    buffer_load_dwordx4 v[44:47], v3, s[8:11], 0 offen offset:3072 nt
    buffer_load_dwordx4 v[48:51], v3, s[8:11], s31 offen offset:0 nt
    buffer_load_dwordx4 v[52:55], v3, s[8:11], s31 offen offset:1024 nt
    buffer_load_dwordx4 v[56:59], v3, s[8:11], s31 offen offset:2048 nt
    buffer_load_dwordx4 v[60:63], v3, s[8:11], s31 offen offset:3072 nt
    buffer_load_dwordx4 v[64:67], v3, s[8:11], s32 offen offset:0 nt
    buffer_load_dwordx4 v[68:71], v3, s[8:11], s32 offen offset:1024 nt
    buffer_load_dwordx4 v[72:75], v3, s[8:11], s32 offen offset:2048 nt
    buffer_load_dwordx4 v[76:79], v3, s[8:11], s32 offen offset:3072 nt
    buffer_load_dwordx4 v[80:83], v3, s[8:11], s33 offen offset:0 nt
    buffer_load_dwordx4 v[84:87], v3, s[8:11], s33 offen offset:1024 nt
    buffer_load_dwordx4 v[88:91], v3, s[8:11], s33 offen offset:2048 nt
    buffer_load_dwordx4 v[92:95], v3, s[8:11], s33 offen offset:3072 nt
    s_waitcnt vmcnt(16)
    v_add_f32 v8, v8, v16
    v_add_f32 v9, v9, v17
    v_add_f32 v10, v10, v18
    v_add_f32 v11, v11, v19
    v_add_f32 v12, v12, v20
    v_add_f32 v13, v13, v21
    v_add_f32 v14, v14, v22
    v_add_f32 v15, v15, v23
    v_cvt_pk_bf16_f32 v24, v8, v9
    v_cvt_pk_bf16_f32 v25, v10, v11
    v_cvt_pk_bf16_f32 v26, v12, v13
    v_cvt_pk_bf16_f32 v27, v14, v15
    buffer_load_dwordx4 v[96:99], v3, s[12:15], 0 offen offset:0 nt
    buffer_load_dwordx4 v[100:103], v3, s[12:15], 0 offen offset:1024 nt
    buffer_load_dwordx4 v[104:107], v3, s[12:15], 0 offen offset:2048 nt
    buffer_load_dwordx4 v[108:111], v3, s[12:15], 0 offen offset:3072 nt
    buffer_load_dwordx4 v[112:115], v3, s[12:15], s31 offen offset:0 nt
    buffer_load_dwordx4 v[116:119], v3, s[12:15], s31 offen offset:1024 nt
    buffer_load_dwordx4 v[120:123], v3, s[12:15], s31 offen offset:2048 nt
    buffer_load_dwordx4 v[124:127], v3, s[12:15], s31 offen offset:3072 nt
    buffer_load_dwordx4 v[128:131], v3, s[12:15], s32 offen offset:0 nt
    buffer_load_dwordx4 v[132:135], v3, s[12:15], s32 offen offset:1024 nt
    buffer_load_dwordx4 v[136:139], v3, s[12:15], s32 offen offset:2048 nt
    buffer_load_dwordx4 v[140:143], v3, s[12:15], s32 offen offset:3072 nt
    buffer_load_dwordx4 v[144:147], v3, s[12:15], s33 offen offset:0 nt
    buffer_load_dwordx4 v[148:151], v3, s[12:15], s33 offen offset:1024 nt
    buffer_load_dwordx4 v[152:155], v3, s[12:15], s33 offen offset:2048 nt
    buffer_load_dwordx4 v[156:159], v3, s[12:15], s33 offen offset:3072 nt
    s_waitcnt vmcnt(31)
    v_mov_b32 v8, 0
    v_dot2c_f32_bf16 v8, v32, v24
    v_dot2c_f32_bf16 v8, v33, v25
    v_dot2c_f32_bf16 v8, v34, v26
    v_dot2c_f32_bf16 v8, v35, v27
    s_waitcnt vmcnt(30)
    v_mov_b32 v9, 0
    v_dot2c_f32_bf16 v9, v36, v24
    v_dot2c_f32_bf16 v9, v37, v25
    v_dot2c_f32_bf16 v9, v38, v26
    v_dot2c_f32_bf16 v9, v39, v27
    s_waitcnt vmcnt(29)
    v_mov_b32 v10, 0
    v_dot2c_f32_bf16 v10, v40, v24
    v_dot2c_f32_bf16 v10, v41, v25
    v_dot2c_f32_bf16 v10, v42, v26
    v_dot2c_f32_bf16 v10, v43, v27
    s_waitcnt vmcnt(28)
    v_mov_b32 v11, 0
    v_dot2c_f32_bf16 v11, v44, v24
    v_dot2c_f32_bf16 v11, v45, v25
    v_dot2c_f32_bf16 v11, v46, v26
    v_dot2c_f32_bf16 v11, v47, v27
    s_waitcnt vmcnt(27)
    v_mov_b32 v12, 0
    v_dot2c_f32_bf16 v12, v48, v24
    v_dot2c_f32_bf16 v12, v49, v25
    v_dot2c_f32_bf16 v12, v50, v26
    v_dot2c_f32_bf16 v12, v51, v27
    s_waitcnt vmcnt(26)
    v_mov_b32 v13, 0
    v_dot2c_f32_bf16 v13, v52, v24
    v_dot2c_f32_bf16 v13, v53, v25
    v_dot2c_f32_bf16 v13, v54, v26
    v_dot2c_f32_bf16 v13, v55, v27
    s_waitcnt vmcnt(25)
    v_mov_b32 v14, 0
    v_dot2c_f32_bf16 v14, v56, v24
    v_dot2c_f32_bf16 v14, v57, v25
    v_dot2c_f32_bf16 v14, v58, v26
    v_dot2c_f32_bf16 v14, v59, v27
    s_waitcnt vmcnt(24)
    v_mov_b32 v15, 0
    v_dot2c_f32_bf16 v15, v60, v24
    v_dot2c_f32_bf16 v15, v61, v25
    v_dot2c_f32_bf16 v15, v62, v26
    v_dot2c_f32_bf16 v15, v63, v27
    s_waitcnt vmcnt(23)
    v_mov_b32 v16, 0
    v_dot2c_f32_bf16 v16, v64, v24
    v_dot2c_f32_bf16 v16, v65, v25
    v_dot2c_f32_bf16 v16, v66, v26
    v_dot2c_f32_bf16 v16, v67, v27
    s_waitcnt vmcnt(22)
    v_mov_b32 v17, 0
    v_dot2c_f32_bf16 v17, v68, v24
    v_dot2c_f32_bf16 v17, v69, v25
    v_dot2c_f32_bf16 v17, v70, v26
    v_dot2c_f32_bf16 v17, v71, v27
    s_waitcnt vmcnt(21)
    v_mov_b32 v18, 0
    v_dot2c_f32_bf16 v18, v72, v24
    v_dot2c_f32_bf16 v18, v73, v25
    v_dot2c_f32_bf16 v18, v74, v26
    v_dot2c_f32_bf16 v18, v75, v27
    s_waitcnt vmcnt(20)
    v_mov_b32 v19, 0
    v_dot2c_f32_bf16 v19, v76, v24
    v_dot2c_f32_bf16 v19, v77, v25
    v_dot2c_f32_bf16 v19, v78, v26
    v_dot2c_f32_bf16 v19, v79, v27
    s_waitcnt vmcnt(19)
    v_mov_b32 v20, 0
    v_dot2c_f32_bf16 v20, v80, v24
    v_dot2c_f32_bf16 v20, v81, v25
    v_dot2c_f32_bf16 v20, v82, v26
    v_dot2c_f32_bf16 v20, v83, v27
    s_waitcnt vmcnt(18)
    v_mov_b32 v21, 0
    v_dot2c_f32_bf16 v21, v84, v24
    v_dot2c_f32_bf16 v21, v85, v25
    v_dot2c_f32_bf16 v21, v86, v26
    v_dot2c_f32_bf16 v21, v87, v27
    s_waitcnt vmcnt(17)
    v_mov_b32 v22, 0
    v_dot2c_f32_bf16 v22, v88, v24
    v_dot2c_f32_bf16 v22, v89, v25
    v_dot2c_f32_bf16 v22, v90, v26
    v_dot2c_f32_bf16 v22, v91, v27
    s_waitcnt vmcnt(16)
    v_mov_b32 v23, 0
    v_dot2c_f32_bf16 v23, v92, v24
    v_dot2c_f32_bf16 v23, v93, v25
    v_dot2c_f32_bf16 v23, v94, v26
    v_dot2c_f32_bf16 v23, v95, v27
    v_add_f32_dpp v8, v8, v8 row_ror:8 row_mask:0xf bank_mask:0xf
    v_add_f32_dpp v9, v9, v9 row_ror:8 row_mask:0xf bank_mask:0xf
    v_add_f32_dpp v10, v10, v10 row_ror:8 row_mask:0xf bank_mask:0xf
    v_add_f32_dpp v11, v11, v11 row_ror:8 row_mask:0xf bank_mask:0xf
    v_add_f32_dpp v12, v12, v12 row_ror:8 row_mask:0xf bank_mask:0xf
    v_add_f32_dpp v13, v13, v13 row_ror:8 row_mask:0xf bank_mask:0xf
    v_add_f32_dpp v14, v14, v14 row_ror:8 row_mask:0xf bank_mask:0xf
    v_add_f32_dpp v15, v15, v15 row_ror:8 row_mask:0xf bank_mask:0xf
    v_add_f32_dpp v16, v16, v16 row_ror:8 row_mask:0xf bank_mask:0xf
    v_add_f32_dpp v17, v17, v17 row_ror:8 row_mask:0xf bank_mask:0xf
    v_add_f32_dpp v18, v18, v18 row_ror:8 row_mask:0xf bank_mask:0xf
    v_add_f32_dpp v19, v19, v19 row_ror:8 row_mask:0xf bank_mask:0xf
    v_add_f32_dpp v20, v20, v20 row_ror:8 row_mask:0xf bank_mask:0xf
    v_add_f32_dpp v21, v21, v21 row_ror:8 row_mask:0xf bank_mask:0xf
    v_add_f32_dpp v22, v22, v22 row_ror:8 row_mask:0xf bank_mask:0xf
    v_add_f32_dpp v23, v23, v23 row_ror:8 row_mask:0xf bank_mask:0xf
    v_add_f32_dpp v8, v8, v8 row_ror:4 row_mask:0xf bank_mask:0xf
    v_add_f32_dpp v9, v9, v9 row_ror:4 row_mask:0xf bank_mask:0xf
    v_add_f32_dpp v10, v10, v10 row_ror:4 row_mask:0xf bank_mask:0xf
    v_add_f32_dpp v11, v11, v11 row_ror:4 row_mask:0xf bank_mask:0xf
    v_add_f32_dpp v12, v12, v12 row_ror:4 row_mask:0xf bank_mask:0xf
    v_add_f32_dpp v13, v13, v13 row_ror:4 row_mask:0xf bank_mask:0xf
    v_add_f32_dpp v14, v14, v14 row_ror:4 row_mask:0xf bank_mask:0xf
    v_add_f32_dpp v15, v15, v15 row_ror:4 row_mask:0xf bank_mask:0xf
    v_add_f32_dpp v16, v16, v16 row_ror:4 row_mask:0xf bank_mask:0xf
    v_add_f32_dpp v17, v17, v17 row_ror:4 row_mask:0xf bank_mask:0xf
    v_add_f32_dpp v18, v18, v18 row_ror:4 row_mask:0xf bank_mask:0xf
    v_add_f32_dpp v19, v19, v19 row_ror:4 row_mask:0xf bank_mask:0xf
    v_add_f32_dpp v20, v20, v20 row_ror:4 row_mask:0xf bank_mask:0xf
    v_add_f32_dpp v21, v21, v21 row_ror:4 row_mask:0xf bank_mask:0xf
    v_add_f32_dpp v22, v22, v22 row_ror:4 row_mask:0xf bank_mask:0xf
    v_add_f32_dpp v23, v23, v23 row_ror:4 row_mask:0xf bank_mask:0xf
    v_add_f32_dpp v8, v8, v8 row_ror:2 row_mask:0xf bank_mask:0xf
    v_add_f32_dpp v9, v9, v9 row_ror:2 row_mask:0xf bank_mask:0xf
    v_add_f32_dpp v10, v10, v10 row_ror:2 row_mask:0xf bank_mask:0xf
    v_add_f32_dpp v11, v11, v11 row_ror:2 row_mask:0xf bank_mask:0xf
    v_add_f32_dpp v12, v12, v12 row_ror:2 row_mask:0xf bank_mask:0xf
    v_add_f32_dpp v13, v13, v13 row_ror:2 row_mask:0xf bank_mask:0xf
    v_add_f32_dpp v14, v14, v14 row_ror:2 row_mask:0xf bank_mask:0xf
    v_add_f32_dpp v15, v15, v15 row_ror:2 row_mask:0xf bank_mask:0xf
    v_add_f32_dpp v16, v16, v16 row_ror:2 row_mask:0xf bank_mask:0xf
    v_add_f32_dpp v17, v17, v17 row_ror:2 row_mask:0xf bank_mask:0xf
    v_add_f32_dpp v18, v18, v18 row_ror:2 row_mask:0xf bank_mask:0xf
    v_add_f32_dpp v19, v19, v19 row_ror:2 row_mask:0xf bank_mask:0xf
    v_add_f32_dpp v20, v20, v20 row_ror:2 row_mask:0xf bank_mask:0xf
    v_add_f32_dpp v21, v21, v21 row_ror:2 row_mask:0xf bank_mask:0xf
    v_add_f32_dpp v22, v22, v22 row_ror:2 row_mask:0xf bank_mask:0xf
    v_add_f32_dpp v23, v23, v23 row_ror:2 row_mask:0xf bank_mask:0xf
    v_add_f32_dpp v8, v8, v8 row_ror:1 row_mask:0xf bank_mask:0xf
    v_add_f32_dpp v9, v9, v9 row_ror:1 row_mask:0xf bank_mask:0xf
    v_add_f32_dpp v10, v10, v10 row_ror:1 row_mask:0xf bank_mask:0xf
    v_add_f32_dpp v11, v11, v11 row_ror:1 row_mask:0xf bank_mask:0xf
    v_add_f32_dpp v12, v12, v12 row_ror:1 row_mask:0xf bank_mask:0xf
    v_add_f32_dpp v13, v13, v13 row_ror:1 row_mask:0xf bank_mask:0xf
    v_add_f32_dpp v14, v14, v14 row_ror:1 row_mask:0xf bank_mask:0xf
    v_add_f32_dpp v15, v15, v15 row_ror:1 row_mask:0xf bank_mask:0xf
    v_add_f32_dpp v16, v16, v16 row_ror:1 row_mask:0xf bank_mask:0xf
    v_add_f32_dpp v17, v17, v17 row_ror:1 row_mask:0xf bank_mask:0xf
    v_add_f32_dpp v18, v18, v18 row_ror:1 row_mask:0xf bank_mask:0xf
    v_add_f32_dpp v19, v19, v19 row_ror:1 row_mask:0xf bank_mask:0xf
    v_add_f32_dpp v20, v20, v20 row_ror:1 row_mask:0xf bank_mask:0xf
    v_add_f32_dpp v21, v21, v21 row_ror:1 row_mask:0xf bank_mask:0xf
    v_add_f32_dpp v22, v22, v22 row_ror:1 row_mask:0xf bank_mask:0xf
    v_add_f32_dpp v23, v23, v23 row_ror:1 row_mask:0xf bank_mask:0xf
    s_mov_b32 s34, 0x3db504f3
    v_cvt_pk_bf16_f32 v32, v8, v9
    v_and_b32 v33, 0xffff0000, v32
    v_lshlrev_b32 v32, 16, v32
    v_cvt_pk_bf16_f32 v34, v10, v11
    v_and_b32 v35, 0xffff0000, v34
    v_lshlrev_b32 v34, 16, v34
    v_cvt_pk_bf16_f32 v36, v12, v13
    v_and_b32 v37, 0xffff0000, v36
    v_lshlrev_b32 v36, 16, v36
    v_cvt_pk_bf16_f32 v38, v14, v15
    v_and_b32 v39, 0xffff0000, v38
    v_lshlrev_b32 v38, 16, v38
    v_cvt_pk_bf16_f32 v40, v16, v17
    v_and_b32 v41, 0xffff0000, v40
    v_lshlrev_b32 v40, 16, v40
    v_cvt_pk_bf16_f32 v42, v18, v19
    v_and_b32 v43, 0xffff0000, v42
    v_lshlrev_b32 v42, 16, v42
    v_cvt_pk_bf16_f32 v44, v20, v21
    v_and_b32 v45, 0xffff0000, v44
    v_lshlrev_b32 v44, 16, v44
    v_cvt_pk_bf16_f32 v46, v22, v23
    v_and_b32 v47, 0xffff0000, v46
    v_lshlrev_b32 v46, 16, v46
    v_mul_f32 v32, s34, v32
    v_mul_f32 v33, s34, v33
    v_mul_f32 v34, s34, v34
    v_mul_f32 v35, s34, v35
    v_mul_f32 v36, s34, v36
    v_mul_f32 v37, s34, v37
    v_mul_f32 v38, s34, v38
    v_mul_f32 v39, s34, v39
    v_mul_f32 v40, s34, v40
    v_mul_f32 v41, s34, v41
    v_mul_f32 v42, s34, v42
    v_mul_f32 v43, s34, v43
    v_mul_f32 v44, s34, v44
    v_mul_f32 v45, s34, v45
    v_mul_f32 v46, s34, v46
    v_mul_f32 v47, s34, v47
    v_cvt_pk_bf16_f32 v8, v32, v33
    v_and_b32 v9, 0xffff0000, v8
    v_lshlrev_b32 v8, 16, v8
    v_cvt_pk_bf16_f32 v10, v34, v35
    v_and_b32 v11, 0xffff0000, v10
    v_lshlrev_b32 v10, 16, v10
    v_cvt_pk_bf16_f32 v12, v36, v37
    v_and_b32 v13, 0xffff0000, v12
    v_lshlrev_b32 v12, 16, v12
    v_cvt_pk_bf16_f32 v14, v38, v39
    v_and_b32 v15, 0xffff0000, v14
    v_lshlrev_b32 v14, 16, v14
    v_cvt_pk_bf16_f32 v16, v40, v41
    v_and_b32 v17, 0xffff0000, v16
    v_lshlrev_b32 v16, 16, v16
    v_cvt_pk_bf16_f32 v18, v42, v43
    v_and_b32 v19, 0xffff0000, v18
    v_lshlrev_b32 v18, 16, v18
    v_cvt_pk_bf16_f32 v20, v44, v45
    v_and_b32 v21, 0xffff0000, v20
    v_lshlrev_b32 v20, 16, v20
    v_cvt_pk_bf16_f32 v22, v46, v47
    v_and_b32 v23, 0xffff0000, v22
    v_lshlrev_b32 v22, 16, v22
    v_max_f32 v28, v8, v9
    v_max_f32 v28, v28, v10
    v_max_f32 v28, v28, v11
    v_max_f32 v28, v28, v12
    v_max_f32 v28, v28, v13
    v_max_f32 v28, v28, v14
    v_max_f32 v28, v28, v15
    v_max_f32 v28, v28, v16
    v_max_f32 v28, v28, v17
    v_max_f32 v28, v28, v18
    v_max_f32 v28, v28, v19
    v_max_f32 v28, v28, v20
    v_max_f32 v28, v28, v21
    v_max_f32 v28, v28, v22
    v_max_f32 v28, v28, v23
    s_mov_b32 s35, 0x3fb8aa3b
    v_sub_f32 v8, v8, v28
    v_sub_f32 v9, v9, v28
    v_sub_f32 v10, v10, v28
    v_sub_f32 v11, v11, v28
    v_sub_f32 v12, v12, v28
    v_sub_f32 v13, v13, v28
    v_sub_f32 v14, v14, v28
    v_sub_f32 v15, v15, v28
    v_sub_f32 v16, v16, v28
    v_sub_f32 v17, v17, v28
    v_sub_f32 v18, v18, v28
    v_sub_f32 v19, v19, v28
    v_sub_f32 v20, v20, v28
    v_sub_f32 v21, v21, v28
    v_sub_f32 v22, v22, v28
    v_sub_f32 v23, v23, v28
    v_mul_f32 v8, s35, v8
    v_mul_f32 v9, s35, v9
    v_mul_f32 v10, s35, v10
    v_mul_f32 v11, s35, v11
    v_mul_f32 v12, s35, v12
    v_mul_f32 v13, s35, v13
    v_mul_f32 v14, s35, v14
    v_mul_f32 v15, s35, v15
    v_mul_f32 v16, s35, v16
    v_mul_f32 v17, s35, v17
    v_mul_f32 v18, s35, v18
    v_mul_f32 v19, s35, v19
    v_mul_f32 v20, s35, v20
    v_mul_f32 v21, s35, v21
    v_mul_f32 v22, s35, v22
    v_mul_f32 v23, s35, v23
    v_exp_f32 v8, v8
    v_exp_f32 v9, v9
    v_exp_f32 v10, v10
    v_exp_f32 v11, v11
    v_exp_f32 v12, v12
    v_exp_f32 v13, v13
    v_exp_f32 v14, v14
    v_exp_f32 v15, v15
    v_exp_f32 v16, v16
    v_exp_f32 v17, v17
    v_exp_f32 v18, v18
    v_exp_f32 v19, v19
    v_exp_f32 v20, v20
    v_exp_f32 v21, v21
    v_exp_f32 v22, v22
    v_exp_f32 v23, v23
    v_add_f32 v29, v8, v9
    v_add_f32 v29, v29, v10
    v_add_f32 v29, v29, v11
    v_add_f32 v29, v29, v12
    v_add_f32 v29, v29, v13
    v_add_f32 v29, v29, v14
    v_add_f32 v29, v29, v15
    v_add_f32 v29, v29, v16
    v_add_f32 v29, v29, v17
    v_add_f32 v29, v29, v18
    v_add_f32 v29, v29, v19
    v_add_f32 v29, v29, v20
    v_add_f32 v29, v29, v21
    v_add_f32 v29, v29, v22
    v_add_f32 v29, v29, v23
    v_mov_b32 v32, 0
    v_mov_b32 v33, 0
    v_mov_b32 v34, 0
    v_mov_b32 v35, 0
    v_mov_b32 v36, 0
    v_mov_b32 v37, 0
    v_mov_b32 v38, 0
    v_mov_b32 v39, 0
    s_waitcnt vmcnt(15)
    v_lshlrev_b32 v40, 16, v96
    v_and_b32 v41, 0xffff0000, v96
    v_fmac_f32 v32, v40, v8
    v_fmac_f32 v33, v41, v8
    v_lshlrev_b32 v40, 16, v97
    v_and_b32 v41, 0xffff0000, v97
    v_fmac_f32 v34, v40, v8
    v_fmac_f32 v35, v41, v8
    v_lshlrev_b32 v40, 16, v98
    v_and_b32 v41, 0xffff0000, v98
    v_fmac_f32 v36, v40, v8
    v_fmac_f32 v37, v41, v8
    v_lshlrev_b32 v40, 16, v99
    v_and_b32 v41, 0xffff0000, v99
    v_fmac_f32 v38, v40, v8
    v_fmac_f32 v39, v41, v8
    s_waitcnt vmcnt(14)
    v_lshlrev_b32 v40, 16, v100
    v_and_b32 v41, 0xffff0000, v100
    v_fmac_f32 v32, v40, v9
    v_fmac_f32 v33, v41, v9
    v_lshlrev_b32 v40, 16, v101
    v_and_b32 v41, 0xffff0000, v101
    v_fmac_f32 v34, v40, v9
    v_fmac_f32 v35, v41, v9
    v_lshlrev_b32 v40, 16, v102
    v_and_b32 v41, 0xffff0000, v102
    v_fmac_f32 v36, v40, v9
    v_fmac_f32 v37, v41, v9
    v_lshlrev_b32 v40, 16, v103
    v_and_b32 v41, 0xffff0000, v103
    v_fmac_f32 v38, v40, v9
    v_fmac_f32 v39, v41, v9
    s_waitcnt vmcnt(13)
    v_lshlrev_b32 v40, 16, v104
    v_and_b32 v41, 0xffff0000, v104
    v_fmac_f32 v32, v40, v10
    v_fmac_f32 v33, v41, v10
    v_lshlrev_b32 v40, 16, v105
    v_and_b32 v41, 0xffff0000, v105
    v_fmac_f32 v34, v40, v10
    v_fmac_f32 v35, v41, v10
    v_lshlrev_b32 v40, 16, v106
    v_and_b32 v41, 0xffff0000, v106
    v_fmac_f32 v36, v40, v10
    v_fmac_f32 v37, v41, v10
    v_lshlrev_b32 v40, 16, v107
    v_and_b32 v41, 0xffff0000, v107
    v_fmac_f32 v38, v40, v10
    v_fmac_f32 v39, v41, v10
    s_waitcnt vmcnt(12)
    v_lshlrev_b32 v40, 16, v108
    v_and_b32 v41, 0xffff0000, v108
    v_fmac_f32 v32, v40, v11
    v_fmac_f32 v33, v41, v11
    v_lshlrev_b32 v40, 16, v109
    v_and_b32 v41, 0xffff0000, v109
    v_fmac_f32 v34, v40, v11
    v_fmac_f32 v35, v41, v11
    v_lshlrev_b32 v40, 16, v110
    v_and_b32 v41, 0xffff0000, v110
    v_fmac_f32 v36, v40, v11
    v_fmac_f32 v37, v41, v11
    v_lshlrev_b32 v40, 16, v111
    v_and_b32 v41, 0xffff0000, v111
    v_fmac_f32 v38, v40, v11
    v_fmac_f32 v39, v41, v11
    s_waitcnt vmcnt(11)
    v_lshlrev_b32 v40, 16, v112
    v_and_b32 v41, 0xffff0000, v112
    v_fmac_f32 v32, v40, v12
    v_fmac_f32 v33, v41, v12
    v_lshlrev_b32 v40, 16, v113
    v_and_b32 v41, 0xffff0000, v113
    v_fmac_f32 v34, v40, v12
    v_fmac_f32 v35, v41, v12
    v_lshlrev_b32 v40, 16, v114
    v_and_b32 v41, 0xffff0000, v114
    v_fmac_f32 v36, v40, v12
    v_fmac_f32 v37, v41, v12
    v_lshlrev_b32 v40, 16, v115
    v_and_b32 v41, 0xffff0000, v115
    v_fmac_f32 v38, v40, v12
    v_fmac_f32 v39, v41, v12
    s_waitcnt vmcnt(10)
    v_lshlrev_b32 v40, 16, v116
    v_and_b32 v41, 0xffff0000, v116
    v_fmac_f32 v32, v40, v13
    v_fmac_f32 v33, v41, v13
    v_lshlrev_b32 v40, 16, v117
    v_and_b32 v41, 0xffff0000, v117
    v_fmac_f32 v34, v40, v13
    v_fmac_f32 v35, v41, v13
    v_lshlrev_b32 v40, 16, v118
    v_and_b32 v41, 0xffff0000, v118
    v_fmac_f32 v36, v40, v13
    v_fmac_f32 v37, v41, v13
    v_lshlrev_b32 v40, 16, v119
    v_and_b32 v41, 0xffff0000, v119
    v_fmac_f32 v38, v40, v13
    v_fmac_f32 v39, v41, v13
    s_waitcnt vmcnt(9)
    v_lshlrev_b32 v40, 16, v120
    v_and_b32 v41, 0xffff0000, v120
    v_fmac_f32 v32, v40, v14
    v_fmac_f32 v33, v41, v14
    v_lshlrev_b32 v40, 16, v121
    v_and_b32 v41, 0xffff0000, v121
    v_fmac_f32 v34, v40, v14
    v_fmac_f32 v35, v41, v14
    v_lshlrev_b32 v40, 16, v122
    v_and_b32 v41, 0xffff0000, v122
    v_fmac_f32 v36, v40, v14
    v_fmac_f32 v37, v41, v14
    v_lshlrev_b32 v40, 16, v123
    v_and_b32 v41, 0xffff0000, v123
    v_fmac_f32 v38, v40, v14
    v_fmac_f32 v39, v41, v14
    s_waitcnt vmcnt(8)
    v_lshlrev_b32 v40, 16, v124
    v_and_b32 v41, 0xffff0000, v124
    v_fmac_f32 v32, v40, v15
    v_fmac_f32 v33, v41, v15
    v_lshlrev_b32 v40, 16, v125
    v_and_b32 v41, 0xffff0000, v125
    v_fmac_f32 v34, v40, v15
    v_fmac_f32 v35, v41, v15
    v_lshlrev_b32 v40, 16, v126
    v_and_b32 v41, 0xffff0000, v126
    v_fmac_f32 v36, v40, v15
    v_fmac_f32 v37, v41, v15
    v_lshlrev_b32 v40, 16, v127
    v_and_b32 v41, 0xffff0000, v127
    v_fmac_f32 v38, v40, v15
    v_fmac_f32 v39, v41, v15
    s_waitcnt vmcnt(7)
    v_lshlrev_b32 v40, 16, v128
    v_and_b32 v41, 0xffff0000, v128
    v_fmac_f32 v32, v40, v16
    v_fmac_f32 v33, v41, v16
    v_lshlrev_b32 v40, 16, v129
    v_and_b32 v41, 0xffff0000, v129
    v_fmac_f32 v34, v40, v16
    v_fmac_f32 v35, v41, v16
    v_lshlrev_b32 v40, 16, v130
    v_and_b32 v41, 0xffff0000, v130
    v_fmac_f32 v36, v40, v16
    v_fmac_f32 v37, v41, v16
    v_lshlrev_b32 v40, 16, v131
    v_and_b32 v41, 0xffff0000, v131
    v_fmac_f32 v38, v40, v16
    v_fmac_f32 v39, v41, v16
    s_waitcnt vmcnt(6)
    v_lshlrev_b32 v40, 16, v132
    v_and_b32 v41, 0xffff0000, v132
    v_fmac_f32 v32, v40, v17
    v_fmac_f32 v33, v41, v17
    v_lshlrev_b32 v40, 16, v133
    v_and_b32 v41, 0xffff0000, v133
    v_fmac_f32 v34, v40, v17
    v_fmac_f32 v35, v41, v17
    v_lshlrev_b32 v40, 16, v134
    v_and_b32 v41, 0xffff0000, v134
    v_fmac_f32 v36, v40, v17
    v_fmac_f32 v37, v41, v17
    v_lshlrev_b32 v40, 16, v135
    v_and_b32 v41, 0xffff0000, v135
    v_fmac_f32 v38, v40, v17
    v_fmac_f32 v39, v41, v17
    s_waitcnt vmcnt(5)
    v_lshlrev_b32 v40, 16, v136
    v_and_b32 v41, 0xffff0000, v136
    v_fmac_f32 v32, v40, v18
    v_fmac_f32 v33, v41, v18
    v_lshlrev_b32 v40, 16, v137
    v_and_b32 v41, 0xffff0000, v137
    v_fmac_f32 v34, v40, v18
    v_fmac_f32 v35, v41, v18
    v_lshlrev_b32 v40, 16, v138
    v_and_b32 v41, 0xffff0000, v138
    v_fmac_f32 v36, v40, v18
    v_fmac_f32 v37, v41, v18
    v_lshlrev_b32 v40, 16, v139
    v_and_b32 v41, 0xffff0000, v139
    v_fmac_f32 v38, v40, v18
    v_fmac_f32 v39, v41, v18
    s_waitcnt vmcnt(4)
    v_lshlrev_b32 v40, 16, v140
    v_and_b32 v41, 0xffff0000, v140
    v_fmac_f32 v32, v40, v19
    v_fmac_f32 v33, v41, v19
    v_lshlrev_b32 v40, 16, v141
    v_and_b32 v41, 0xffff0000, v141
    v_fmac_f32 v34, v40, v19
    v_fmac_f32 v35, v41, v19
    v_lshlrev_b32 v40, 16, v142
    v_and_b32 v41, 0xffff0000, v142
    v_fmac_f32 v36, v40, v19
    v_fmac_f32 v37, v41, v19
    v_lshlrev_b32 v40, 16, v143
    v_and_b32 v41, 0xffff0000, v143
    v_fmac_f32 v38, v40, v19
    v_fmac_f32 v39, v41, v19
    s_waitcnt vmcnt(3)
    v_lshlrev_b32 v40, 16, v144
    v_and_b32 v41, 0xffff0000, v144
    v_fmac_f32 v32, v40, v20
    v_fmac_f32 v33, v41, v20
    v_lshlrev_b32 v40, 16, v145
    v_and_b32 v41, 0xffff0000, v145
    v_fmac_f32 v34, v40, v20
    v_fmac_f32 v35, v41, v20
    v_lshlrev_b32 v40, 16, v146
    v_and_b32 v41, 0xffff0000, v146
    v_fmac_f32 v36, v40, v20
    v_fmac_f32 v37, v41, v20
    v_lshlrev_b32 v40, 16, v147
    v_and_b32 v41, 0xffff0000, v147
    v_fmac_f32 v38, v40, v20
    v_fmac_f32 v39, v41, v20
    s_waitcnt vmcnt(2)
    v_lshlrev_b32 v40, 16, v148
    v_and_b32 v41, 0xffff0000, v148
    v_fmac_f32 v32, v40, v21
    v_fmac_f32 v33, v41, v21
    v_lshlrev_b32 v40, 16, v149
    v_and_b32 v41, 0xffff0000, v149
    v_fmac_f32 v34, v40, v21
    v_fmac_f32 v35, v41, v21
    v_lshlrev_b32 v40, 16, v150
    v_and_b32 v41, 0xffff0000, v150
    v_fmac_f32 v36, v40, v21
    v_fmac_f32 v37, v41, v21
    v_lshlrev_b32 v40, 16, v151
    v_and_b32 v41, 0xffff0000, v151
    v_fmac_f32 v38, v40, v21
    v_fmac_f32 v39, v41, v21
    s_waitcnt vmcnt(1)
    v_lshlrev_b32 v40, 16, v152
    v_and_b32 v41, 0xffff0000, v152
    v_fmac_f32 v32, v40, v22
    v_fmac_f32 v33, v41, v22
    v_lshlrev_b32 v40, 16, v153
    v_and_b32 v41, 0xffff0000, v153
    v_fmac_f32 v34, v40, v22
    v_fmac_f32 v35, v41, v22
    v_lshlrev_b32 v40, 16, v154
    v_and_b32 v41, 0xffff0000, v154
    v_fmac_f32 v36, v40, v22
    v_fmac_f32 v37, v41, v22
    v_lshlrev_b32 v40, 16, v155
    v_and_b32 v41, 0xffff0000, v155
    v_fmac_f32 v38, v40, v22
    v_fmac_f32 v39, v41, v22
    s_waitcnt vmcnt(0)
    v_lshlrev_b32 v40, 16, v156
    v_and_b32 v41, 0xffff0000, v156
    v_fmac_f32 v32, v40, v23
    v_fmac_f32 v33, v41, v23
    v_lshlrev_b32 v40, 16, v157
    v_and_b32 v41, 0xffff0000, v157
    v_fmac_f32 v34, v40, v23
    v_fmac_f32 v35, v41, v23
    v_lshlrev_b32 v40, 16, v158
    v_and_b32 v41, 0xffff0000, v158
    v_fmac_f32 v36, v40, v23
    v_fmac_f32 v37, v41, v23
    v_lshlrev_b32 v40, 16, v159
    v_and_b32 v41, 0xffff0000, v159
    v_fmac_f32 v38, v40, v23
    v_fmac_f32 v39, v41, v23
    v_lshrrev_b32 v6, 4, v0
    v_lshlrev_b32 v7, 9, v6
    v_and_b32 v42, 15, v0
    v_lshlrev_b32 v42, 5, v42
    v_add_u32 v7, v7, v42
    ds_write_b128 v7, v[32:35]
    ds_write_b128 v7, v[36:39] offset:16
    v_lshlrev_b32 v43, 3, v6
    ds_write_b64 v43, v[28:29] offset:8192
    s_waitcnt lgkmcnt(0)
    s_barrier
    v_cmp_gt_u32 vcc, 128, v0
    s_and_saveexec_b64 s[26:27], vcc
    s_cbranch_execz L_a_done
    v_mov_b32 v44, 0
    ds_read_b128 v[48:51], v44 offset:8192
    ds_read_b128 v[52:55], v44 offset:8208
    ds_read_b128 v[56:59], v44 offset:8224
    ds_read_b128 v[60:63], v44 offset:8240
    ds_read_b128 v[64:67], v44 offset:8256
    ds_read_b128 v[68:71], v44 offset:8272
    ds_read_b128 v[72:75], v44 offset:8288
    ds_read_b128 v[76:79], v44 offset:8304
    v_lshlrev_b32 v45, 2, v0
    ds_read_b32 v8, v45 offset:0
    ds_read_b32 v9, v45 offset:512
    ds_read_b32 v10, v45 offset:1024
    ds_read_b32 v11, v45 offset:1536
    ds_read_b32 v12, v45 offset:2048
    ds_read_b32 v13, v45 offset:2560
    ds_read_b32 v14, v45 offset:3072
    ds_read_b32 v15, v45 offset:3584
    ds_read_b32 v16, v45 offset:4096
    ds_read_b32 v17, v45 offset:4608
    ds_read_b32 v18, v45 offset:5120
    ds_read_b32 v19, v45 offset:5632
    ds_read_b32 v20, v45 offset:6144
    ds_read_b32 v21, v45 offset:6656
    ds_read_b32 v22, v45 offset:7168
    ds_read_b32 v23, v45 offset:7680
    s_waitcnt lgkmcnt(0)
    v_max_f32 v28, v48, v50
    v_max_f32 v28, v28, v52
    v_max_f32 v28, v28, v54
    v_max_f32 v28, v28, v56
    v_max_f32 v28, v28, v58
    v_max_f32 v28, v28, v60
    v_max_f32 v28, v28, v62
    v_max_f32 v28, v28, v64
    v_max_f32 v28, v28, v66
    v_max_f32 v28, v28, v68
    v_max_f32 v28, v28, v70
    v_max_f32 v28, v28, v72
    v_max_f32 v28, v28, v74
    v_max_f32 v28, v28, v76
    v_max_f32 v28, v28, v78
    v_sub_f32 v48, v48, v28
    v_mul_f32 v48, s35, v48
    v_exp_f32 v48, v48
    v_sub_f32 v50, v50, v28
    v_mul_f32 v50, s35, v50
    v_exp_f32 v50, v50
    v_sub_f32 v52, v52, v28
    v_mul_f32 v52, s35, v52
    v_exp_f32 v52, v52
    v_sub_f32 v54, v54, v28
    v_mul_f32 v54, s35, v54
    v_exp_f32 v54, v54
    v_sub_f32 v56, v56, v28
    v_mul_f32 v56, s35, v56
    v_exp_f32 v56, v56
    v_sub_f32 v58, v58, v28
    v_mul_f32 v58, s35, v58
    v_exp_f32 v58, v58
    v_sub_f32 v60, v60, v28
    v_mul_f32 v60, s35, v60
    v_exp_f32 v60, v60
    v_sub_f32 v62, v62, v28
    v_mul_f32 v62, s35, v62
    v_exp_f32 v62, v62
    v_sub_f32 v64, v64, v28
    v_mul_f32 v64, s35, v64
    v_exp_f32 v64, v64
    v_sub_f32 v66, v66, v28
    v_mul_f32 v66, s35, v66
    v_exp_f32 v66, v66
    v_sub_f32 v68, v68, v28
    v_mul_f32 v68, s35, v68
    v_exp_f32 v68, v68
    v_sub_f32 v70, v70, v28
    v_mul_f32 v70, s35, v70
    v_exp_f32 v70, v70
    v_sub_f32 v72, v72, v28
    v_mul_f32 v72, s35, v72
    v_exp_f32 v72, v72
    v_sub_f32 v74, v74, v28
    v_mul_f32 v74, s35, v74
    v_exp_f32 v74, v74
    v_sub_f32 v76, v76, v28
    v_mul_f32 v76, s35, v76
    v_exp_f32 v76, v76
    v_sub_f32 v78, v78, v28
    v_mul_f32 v78, s35, v78
    v_exp_f32 v78, v78
    v_mov_b32 v29, 0
    v_mov_b32 v30, 0
    v_fmac_f32 v29, v48, v49
    v_fmac_f32 v30, v48, v8
    v_fmac_f32 v29, v50, v51
    v_fmac_f32 v30, v50, v9
    v_fmac_f32 v29, v52, v53
    v_fmac_f32 v30, v52, v10
    v_fmac_f32 v29, v54, v55
    v_fmac_f32 v30, v54, v11
    v_fmac_f32 v29, v56, v57
    v_fmac_f32 v30, v56, v12
    v_fmac_f32 v29, v58, v59
    v_fmac_f32 v30, v58, v13
    v_fmac_f32 v29, v60, v61
    v_fmac_f32 v30, v60, v14
    v_fmac_f32 v29, v62, v63
    v_fmac_f32 v30, v62, v15
    v_fmac_f32 v29, v64, v65
    v_fmac_f32 v30, v64, v16
    v_fmac_f32 v29, v66, v67
    v_fmac_f32 v30, v66, v17
    v_fmac_f32 v29, v68, v69
    v_fmac_f32 v30, v68, v18
    v_fmac_f32 v29, v70, v71
    v_fmac_f32 v30, v70, v19
    v_fmac_f32 v29, v72, v73
    v_fmac_f32 v30, v72, v20
    v_fmac_f32 v29, v74, v75
    v_fmac_f32 v30, v74, v21
    v_fmac_f32 v29, v76, v77
    v_fmac_f32 v30, v76, v22
    v_fmac_f32 v29, v78, v79
    v_fmac_f32 v30, v78, v23
    s_lshl_b32 s36, s2, 9
    s_add_u32 s36, s36, 81920
    buffer_store_dword v30, v45, s[16:19], s36 offen
    v_cmp_eq_u32 vcc, 0, v0
    s_and_saveexec_b64 s[26:27], vcc
    s_cbranch_execz L_a_done
    s_lshl_b32 s36, s2, 3
    s_add_u32 s36, s36, 65536
    buffer_store_dwordx2 v[28:29], v44, s[16:19], s36 offen
L_a_done:
    s_endpgm
.globl oproj_kernel
.p2align 8
.type oproj_kernel,@function
oproj_kernel:
    s_cmp_ge_u32 s2, 320
    s_cbranch_scc1 L_o_done
    s_cmp_ge_u32 s2, 160
    s_cselect_b32 s3, 1, 0
    s_mul_i32 s4, s3, 160
    s_sub_u32 s20, s2, s4
    s_mul_i32 s21, s20, 205
    s_lshr_b32 s21, s21, 11
    s_mul_i32 s22, s21, 10
    s_sub_u32 s22, s20, s22
    s_mul_i32 s4, s3, 40
    s_add_u32 s6, s0, s4
    s_addc_u32 s7, s1, 0
    s_load_dwordx2 s[8:9], s[6:7], 32
    s_load_dwordx2 s[12:13], s[0:1], 80
    s_load_dwordx2 s[40:41], s[0:1], 88
    s_load_dwordx2 s[16:17], s[0:1], 96
    v_lshrrev_b32 v2, 7, v0
    v_and_b32 v3, 127, v0
    s_lshl_b32 s23, s21, 1
    v_add_u32 v4, s23, v2
    s_waitcnt lgkmcnt(0)
    s_mov_b32 s10, 5242880
    s_mov_b32 s11, 0x00020000
    s_mov_b32 s14, 2560
    s_mov_b32 s15, 0x00020000
    s_mov_b32 s18, 289409536
    s_mov_b32 s19, 0x00020000
    s_mov_b32 s42, 256
    s_mov_b32 s43, 0x00020000
    s_mov_b32 s35, 0x3fb8aa3b
    s_cmp_eq_u32 s3, 1
    s_cbranch_scc1 L_o_B
    v_mul_u32_u24 v5, 32, v4
    v_lshlrev_b32 v6, 3, v5
    v_lshlrev_b32 v7, 9, v5
    v_lshlrev_b32 v1, 2, v3
    v_add_u32 v7, v7, v1
    s_mov_b32 s24, 65536
    s_mov_b32 s25, 81920
    buffer_load_dwordx4 v[16:19], v6, s[16:19], s24 offen offset:0
    buffer_load_dwordx4 v[20:23], v6, s[16:19], s24 offen offset:16
    buffer_load_dwordx4 v[24:27], v6, s[16:19], s24 offen offset:32
    buffer_load_dwordx4 v[28:31], v6, s[16:19], s24 offen offset:48
    buffer_load_dwordx4 v[32:35], v6, s[16:19], s24 offen offset:64
    buffer_load_dwordx4 v[36:39], v6, s[16:19], s24 offen offset:80
    buffer_load_dwordx4 v[40:43], v6, s[16:19], s24 offen offset:96
    buffer_load_dwordx4 v[44:47], v6, s[16:19], s24 offen offset:112
    buffer_load_dwordx4 v[48:51], v6, s[16:19], s24 offen offset:128
    buffer_load_dwordx4 v[52:55], v6, s[16:19], s24 offen offset:144
    buffer_load_dwordx4 v[56:59], v6, s[16:19], s24 offen offset:160
    buffer_load_dwordx4 v[60:63], v6, s[16:19], s24 offen offset:176
    buffer_load_dwordx4 v[64:67], v6, s[16:19], s24 offen offset:192
    buffer_load_dwordx4 v[68:71], v6, s[16:19], s24 offen offset:208
    buffer_load_dwordx4 v[72:75], v6, s[16:19], s24 offen offset:224
    buffer_load_dwordx4 v[76:79], v6, s[16:19], s24 offen offset:240
    buffer_load_dword v80, v7, s[16:19], s25 offen offset:0
    buffer_load_dword v81, v7, s[16:19], s25 offen offset:512
    buffer_load_dword v82, v7, s[16:19], s25 offen offset:1024
    buffer_load_dword v83, v7, s[16:19], s25 offen offset:1536
    buffer_load_dword v84, v7, s[16:19], s25 offen offset:2048
    buffer_load_dword v85, v7, s[16:19], s25 offen offset:2560
    buffer_load_dword v86, v7, s[16:19], s25 offen offset:3072
    buffer_load_dword v87, v7, s[16:19], s25 offen offset:3584
    s_add_u32 s25, s25, 4096
    buffer_load_dword v88, v7, s[16:19], s25 offen offset:0
    buffer_load_dword v89, v7, s[16:19], s25 offen offset:512
    buffer_load_dword v90, v7, s[16:19], s25 offen offset:1024
    buffer_load_dword v91, v7, s[16:19], s25 offen offset:1536
    buffer_load_dword v92, v7, s[16:19], s25 offen offset:2048
    buffer_load_dword v93, v7, s[16:19], s25 offen offset:2560
    buffer_load_dword v94, v7, s[16:19], s25 offen offset:3072
    buffer_load_dword v95, v7, s[16:19], s25 offen offset:3584
    s_add_u32 s25, s25, 4096
    buffer_load_dword v96, v7, s[16:19], s25 offen offset:0
    buffer_load_dword v97, v7, s[16:19], s25 offen offset:512
    buffer_load_dword v98, v7, s[16:19], s25 offen offset:1024
    buffer_load_dword v99, v7, s[16:19], s25 offen offset:1536
    buffer_load_dword v100, v7, s[16:19], s25 offen offset:2048
    buffer_load_dword v101, v7, s[16:19], s25 offen offset:2560
    buffer_load_dword v102, v7, s[16:19], s25 offen offset:3072
    buffer_load_dword v103, v7, s[16:19], s25 offen offset:3584
    s_add_u32 s25, s25, 4096
    buffer_load_dword v104, v7, s[16:19], s25 offen offset:0
    buffer_load_dword v105, v7, s[16:19], s25 offen offset:512
    buffer_load_dword v106, v7, s[16:19], s25 offen offset:1024
    buffer_load_dword v107, v7, s[16:19], s25 offen offset:1536
    buffer_load_dword v108, v7, s[16:19], s25 offen offset:2048
    buffer_load_dword v109, v7, s[16:19], s25 offen offset:2560
    buffer_load_dword v110, v7, s[16:19], s25 offen offset:3072
    buffer_load_dword v111, v7, s[16:19], s25 offen offset:3584
    s_waitcnt vmcnt(32)
    v_max_f32 v8, v16, v18
    v_max_f32 v8, v8, v20
    v_max_f32 v8, v8, v22
    v_max_f32 v8, v8, v24
    v_max_f32 v8, v8, v26
    v_max_f32 v8, v8, v28
    v_max_f32 v8, v8, v30
    v_max_f32 v8, v8, v32
    v_max_f32 v8, v8, v34
    v_max_f32 v8, v8, v36
    v_max_f32 v8, v8, v38
    v_max_f32 v8, v8, v40
    v_max_f32 v8, v8, v42
    v_max_f32 v8, v8, v44
    v_max_f32 v8, v8, v46
    v_max_f32 v8, v8, v48
    v_max_f32 v8, v8, v50
    v_max_f32 v8, v8, v52
    v_max_f32 v8, v8, v54
    v_max_f32 v8, v8, v56
    v_max_f32 v8, v8, v58
    v_max_f32 v8, v8, v60
    v_max_f32 v8, v8, v62
    v_max_f32 v8, v8, v64
    v_max_f32 v8, v8, v66
    v_max_f32 v8, v8, v68
    v_max_f32 v8, v8, v70
    v_max_f32 v8, v8, v72
    v_max_f32 v8, v8, v74
    v_max_f32 v8, v8, v76
    v_max_f32 v8, v8, v78
    v_sub_f32 v16, v16, v8
    v_mul_f32 v16, s35, v16
    v_exp_f32 v16, v16
    v_sub_f32 v18, v18, v8
    v_mul_f32 v18, s35, v18
    v_exp_f32 v18, v18
    v_sub_f32 v20, v20, v8
    v_mul_f32 v20, s35, v20
    v_exp_f32 v20, v20
    v_sub_f32 v22, v22, v8
    v_mul_f32 v22, s35, v22
    v_exp_f32 v22, v22
    v_sub_f32 v24, v24, v8
    v_mul_f32 v24, s35, v24
    v_exp_f32 v24, v24
    v_sub_f32 v26, v26, v8
    v_mul_f32 v26, s35, v26
    v_exp_f32 v26, v26
    v_sub_f32 v28, v28, v8
    v_mul_f32 v28, s35, v28
    v_exp_f32 v28, v28
    v_sub_f32 v30, v30, v8
    v_mul_f32 v30, s35, v30
    v_exp_f32 v30, v30
    v_sub_f32 v32, v32, v8
    v_mul_f32 v32, s35, v32
    v_exp_f32 v32, v32
    v_sub_f32 v34, v34, v8
    v_mul_f32 v34, s35, v34
    v_exp_f32 v34, v34
    v_sub_f32 v36, v36, v8
    v_mul_f32 v36, s35, v36
    v_exp_f32 v36, v36
    v_sub_f32 v38, v38, v8
    v_mul_f32 v38, s35, v38
    v_exp_f32 v38, v38
    v_sub_f32 v40, v40, v8
    v_mul_f32 v40, s35, v40
    v_exp_f32 v40, v40
    v_sub_f32 v42, v42, v8
    v_mul_f32 v42, s35, v42
    v_exp_f32 v42, v42
    v_sub_f32 v44, v44, v8
    v_mul_f32 v44, s35, v44
    v_exp_f32 v44, v44
    v_sub_f32 v46, v46, v8
    v_mul_f32 v46, s35, v46
    v_exp_f32 v46, v46
    v_sub_f32 v48, v48, v8
    v_mul_f32 v48, s35, v48
    v_exp_f32 v48, v48
    v_sub_f32 v50, v50, v8
    v_mul_f32 v50, s35, v50
    v_exp_f32 v50, v50
    v_sub_f32 v52, v52, v8
    v_mul_f32 v52, s35, v52
    v_exp_f32 v52, v52
    v_sub_f32 v54, v54, v8
    v_mul_f32 v54, s35, v54
    v_exp_f32 v54, v54
    v_sub_f32 v56, v56, v8
    v_mul_f32 v56, s35, v56
    v_exp_f32 v56, v56
    v_sub_f32 v58, v58, v8
    v_mul_f32 v58, s35, v58
    v_exp_f32 v58, v58
    v_sub_f32 v60, v60, v8
    v_mul_f32 v60, s35, v60
    v_exp_f32 v60, v60
    v_sub_f32 v62, v62, v8
    v_mul_f32 v62, s35, v62
    v_exp_f32 v62, v62
    v_sub_f32 v64, v64, v8
    v_mul_f32 v64, s35, v64
    v_exp_f32 v64, v64
    v_sub_f32 v66, v66, v8
    v_mul_f32 v66, s35, v66
    v_exp_f32 v66, v66
    v_sub_f32 v68, v68, v8
    v_mul_f32 v68, s35, v68
    v_exp_f32 v68, v68
    v_sub_f32 v70, v70, v8
    v_mul_f32 v70, s35, v70
    v_exp_f32 v70, v70
    v_sub_f32 v72, v72, v8
    v_mul_f32 v72, s35, v72
    v_exp_f32 v72, v72
    v_sub_f32 v74, v74, v8
    v_mul_f32 v74, s35, v74
    v_exp_f32 v74, v74
    v_sub_f32 v76, v76, v8
    v_mul_f32 v76, s35, v76
    v_exp_f32 v76, v76
    v_sub_f32 v78, v78, v8
    v_mul_f32 v78, s35, v78
    v_exp_f32 v78, v78
    v_mov_b32 v9, 0
    v_mov_b32 v10, 0
    s_waitcnt vmcnt(0)
    v_fmac_f32 v9, v16, v17
    v_fmac_f32 v10, v16, v80
    v_fmac_f32 v9, v18, v19
    v_fmac_f32 v10, v18, v81
    v_fmac_f32 v9, v20, v21
    v_fmac_f32 v10, v20, v82
    v_fmac_f32 v9, v22, v23
    v_fmac_f32 v10, v22, v83
    v_fmac_f32 v9, v24, v25
    v_fmac_f32 v10, v24, v84
    v_fmac_f32 v9, v26, v27
    v_fmac_f32 v10, v26, v85
    v_fmac_f32 v9, v28, v29
    v_fmac_f32 v10, v28, v86
    v_fmac_f32 v9, v30, v31
    v_fmac_f32 v10, v30, v87
    v_fmac_f32 v9, v32, v33
    v_fmac_f32 v10, v32, v88
    v_fmac_f32 v9, v34, v35
    v_fmac_f32 v10, v34, v89
    v_fmac_f32 v9, v36, v37
    v_fmac_f32 v10, v36, v90
    v_fmac_f32 v9, v38, v39
    v_fmac_f32 v10, v38, v91
    v_fmac_f32 v9, v40, v41
    v_fmac_f32 v10, v40, v92
    v_fmac_f32 v9, v42, v43
    v_fmac_f32 v10, v42, v93
    v_fmac_f32 v9, v44, v45
    v_fmac_f32 v10, v44, v94
    v_fmac_f32 v9, v46, v47
    v_fmac_f32 v10, v46, v95
    v_fmac_f32 v9, v48, v49
    v_fmac_f32 v10, v48, v96
    v_fmac_f32 v9, v50, v51
    v_fmac_f32 v10, v50, v97
    v_fmac_f32 v9, v52, v53
    v_fmac_f32 v10, v52, v98
    v_fmac_f32 v9, v54, v55
    v_fmac_f32 v10, v54, v99
    v_fmac_f32 v9, v56, v57
    v_fmac_f32 v10, v56, v100
    v_fmac_f32 v9, v58, v59
    v_fmac_f32 v10, v58, v101
    v_fmac_f32 v9, v60, v61
    v_fmac_f32 v10, v60, v102
    v_fmac_f32 v9, v62, v63
    v_fmac_f32 v10, v62, v103
    v_fmac_f32 v9, v64, v65
    v_fmac_f32 v10, v64, v104
    v_fmac_f32 v9, v66, v67
    v_fmac_f32 v10, v66, v105
    v_fmac_f32 v9, v68, v69
    v_fmac_f32 v10, v68, v106
    v_fmac_f32 v9, v70, v71
    v_fmac_f32 v10, v70, v107
    v_fmac_f32 v9, v72, v73
    v_fmac_f32 v10, v72, v108
    v_fmac_f32 v9, v74, v75
    v_fmac_f32 v10, v74, v109
    v_fmac_f32 v9, v76, v77
    v_fmac_f32 v10, v76, v110
    v_fmac_f32 v9, v78, v79
    v_fmac_f32 v10, v78, v111
    s_branch L_o_common
L_o_B:
    v_mul_u32_u24 v5, 8, v4
    v_lshlrev_b32 v6, 3, v5
    v_lshlrev_b32 v7, 9, v5
    v_lshlrev_b32 v1, 2, v3
    v_add_u32 v7, v7, v1
    s_mov_b32 s24, 73728
    s_mov_b32 s25, 606208
    buffer_load_dwordx4 v[16:19], v6, s[16:19], s24 offen offset:0
    buffer_load_dwordx4 v[20:23], v6, s[16:19], s24 offen offset:16
    buffer_load_dwordx4 v[24:27], v6, s[16:19], s24 offen offset:32
    buffer_load_dwordx4 v[28:31], v6, s[16:19], s24 offen offset:48
    buffer_load_dword v80, v7, s[16:19], s25 offen offset:0
    buffer_load_dword v81, v7, s[16:19], s25 offen offset:512
    buffer_load_dword v82, v7, s[16:19], s25 offen offset:1024
    buffer_load_dword v83, v7, s[16:19], s25 offen offset:1536
    buffer_load_dword v84, v7, s[16:19], s25 offen offset:2048
    buffer_load_dword v85, v7, s[16:19], s25 offen offset:2560
    buffer_load_dword v86, v7, s[16:19], s25 offen offset:3072
    buffer_load_dword v87, v7, s[16:19], s25 offen offset:3584
    s_waitcnt vmcnt(8)
    v_max_f32 v8, v16, v18
    v_max_f32 v8, v8, v20
    v_max_f32 v8, v8, v22
    v_max_f32 v8, v8, v24
    v_max_f32 v8, v8, v26
    v_max_f32 v8, v8, v28
    v_max_f32 v8, v8, v30
    v_sub_f32 v16, v16, v8
    v_mul_f32 v16, s35, v16
    v_exp_f32 v16, v16
    v_sub_f32 v18, v18, v8
    v_mul_f32 v18, s35, v18
    v_exp_f32 v18, v18
    v_sub_f32 v20, v20, v8
    v_mul_f32 v20, s35, v20
    v_exp_f32 v20, v20
    v_sub_f32 v22, v22, v8
    v_mul_f32 v22, s35, v22
    v_exp_f32 v22, v22
    v_sub_f32 v24, v24, v8
    v_mul_f32 v24, s35, v24
    v_exp_f32 v24, v24
    v_sub_f32 v26, v26, v8
    v_mul_f32 v26, s35, v26
    v_exp_f32 v26, v26
    v_sub_f32 v28, v28, v8
    v_mul_f32 v28, s35, v28
    v_exp_f32 v28, v28
    v_sub_f32 v30, v30, v8
    v_mul_f32 v30, s35, v30
    v_exp_f32 v30, v30
    v_mov_b32 v9, 0
    v_mov_b32 v10, 0
    s_waitcnt vmcnt(0)
    v_fmac_f32 v9, v16, v17
    v_fmac_f32 v10, v16, v80
    v_fmac_f32 v9, v18, v19
    v_fmac_f32 v10, v18, v81
    v_fmac_f32 v9, v20, v21
    v_fmac_f32 v10, v20, v82
    v_fmac_f32 v9, v22, v23
    v_fmac_f32 v10, v22, v83
    v_fmac_f32 v9, v24, v25
    v_fmac_f32 v10, v24, v84
    v_fmac_f32 v9, v26, v27
    v_fmac_f32 v10, v26, v85
    v_fmac_f32 v9, v28, v29
    v_fmac_f32 v10, v28, v86
    v_fmac_f32 v9, v30, v31
    v_fmac_f32 v10, v30, v87
L_o_common:
    v_rcp_f32 v9, v9
    s_nop 1
    v_mul_f32 v10, v10, v9
    v_cvt_pk_bf16_f32 v10, v10, v10
    v_lshlrev_b32 v10, 16, v10
    v_lshlrev_b32 v1, 2, v0
    ds_write_b32 v1, v10 offset:8192
    s_waitcnt lgkmcnt(0)
    s_barrier
    v_and_b32 v1, 7, v0
    v_lshrrev_b32 v2, 3, v0
    v_mul_u32_u24 v4, 1280, v2
    v_lshlrev_b32 v5, 4, v1
    v_add_u32 v4, v4, v5
    s_mul_i32 s24, s21, 327680
    s_lshl_b32 s25, s22, 7
    s_add_u32 s24, s24, s25
    v_add_u32 v4, s24, v4
    s_mov_b32 s44, 0
    s_mov_b32 s45, 40960
    s_mov_b32 s46, 81920
    s_mov_b32 s47, 122880
    s_mov_b32 s48, 163840
    s_mov_b32 s49, 204800
    s_mov_b32 s50, 245760
    s_mov_b32 s51, 286720
    buffer_load_dwordx4 v[16:19], v4, s[8:11], s44 offen nt
    buffer_load_dwordx4 v[20:23], v4, s[8:11], s45 offen nt
    buffer_load_dwordx4 v[24:27], v4, s[8:11], s46 offen nt
    buffer_load_dwordx4 v[28:31], v4, s[8:11], s47 offen nt
    buffer_load_dwordx4 v[32:35], v4, s[8:11], s48 offen nt
    buffer_load_dwordx4 v[36:39], v4, s[8:11], s49 offen nt
    buffer_load_dwordx4 v[40:43], v4, s[8:11], s50 offen nt
    buffer_load_dwordx4 v[44:47], v4, s[8:11], s51 offen nt
    v_lshlrev_b32 v6, 2, v2
    ds_read_b32 v60, v6 offset:8192
    ds_read_b32 v61, v6 offset:8320
    ds_read_b32 v62, v6 offset:8448
    ds_read_b32 v63, v6 offset:8576
    ds_read_b32 v64, v6 offset:8704
    ds_read_b32 v65, v6 offset:8832
    ds_read_b32 v66, v6 offset:8960
    ds_read_b32 v67, v6 offset:9088
    v_mov_b32 v8, 0
    v_mov_b32 v9, 0
    v_mov_b32 v10, 0
    v_mov_b32 v11, 0
    v_mov_b32 v12, 0
    v_mov_b32 v13, 0
    v_mov_b32 v14, 0
    v_mov_b32 v15, 0
    s_waitcnt lgkmcnt(0)
    s_waitcnt vmcnt(7)
    v_lshlrev_b32 v71, 16, v16
    v_and_b32 v72, 0xffff0000, v16
    v_fmac_f32 v8, v71, v60
    v_fmac_f32 v9, v72, v60
    v_lshlrev_b32 v71, 16, v17
    v_and_b32 v72, 0xffff0000, v17
    v_fmac_f32 v10, v71, v60
    v_fmac_f32 v11, v72, v60
    v_lshlrev_b32 v71, 16, v18
    v_and_b32 v72, 0xffff0000, v18
    v_fmac_f32 v12, v71, v60
    v_fmac_f32 v13, v72, v60
    v_lshlrev_b32 v71, 16, v19
    v_and_b32 v72, 0xffff0000, v19
    v_fmac_f32 v14, v71, v60
    v_fmac_f32 v15, v72, v60
    s_waitcnt vmcnt(6)
    v_lshlrev_b32 v71, 16, v20
    v_and_b32 v72, 0xffff0000, v20
    v_fmac_f32 v8, v71, v61
    v_fmac_f32 v9, v72, v61
    v_lshlrev_b32 v71, 16, v21
    v_and_b32 v72, 0xffff0000, v21
    v_fmac_f32 v10, v71, v61
    v_fmac_f32 v11, v72, v61
    v_lshlrev_b32 v71, 16, v22
    v_and_b32 v72, 0xffff0000, v22
    v_fmac_f32 v12, v71, v61
    v_fmac_f32 v13, v72, v61
    v_lshlrev_b32 v71, 16, v23
    v_and_b32 v72, 0xffff0000, v23
    v_fmac_f32 v14, v71, v61
    v_fmac_f32 v15, v72, v61
    s_waitcnt vmcnt(5)
    v_lshlrev_b32 v71, 16, v24
    v_and_b32 v72, 0xffff0000, v24
    v_fmac_f32 v8, v71, v62
    v_fmac_f32 v9, v72, v62
    v_lshlrev_b32 v71, 16, v25
    v_and_b32 v72, 0xffff0000, v25
    v_fmac_f32 v10, v71, v62
    v_fmac_f32 v11, v72, v62
    v_lshlrev_b32 v71, 16, v26
    v_and_b32 v72, 0xffff0000, v26
    v_fmac_f32 v12, v71, v62
    v_fmac_f32 v13, v72, v62
    v_lshlrev_b32 v71, 16, v27
    v_and_b32 v72, 0xffff0000, v27
    v_fmac_f32 v14, v71, v62
    v_fmac_f32 v15, v72, v62
    s_waitcnt vmcnt(4)
    v_lshlrev_b32 v71, 16, v28
    v_and_b32 v72, 0xffff0000, v28
    v_fmac_f32 v8, v71, v63
    v_fmac_f32 v9, v72, v63
    v_lshlrev_b32 v71, 16, v29
    v_and_b32 v72, 0xffff0000, v29
    v_fmac_f32 v10, v71, v63
    v_fmac_f32 v11, v72, v63
    v_lshlrev_b32 v71, 16, v30
    v_and_b32 v72, 0xffff0000, v30
    v_fmac_f32 v12, v71, v63
    v_fmac_f32 v13, v72, v63
    v_lshlrev_b32 v71, 16, v31
    v_and_b32 v72, 0xffff0000, v31
    v_fmac_f32 v14, v71, v63
    v_fmac_f32 v15, v72, v63
    s_waitcnt vmcnt(3)
    v_lshlrev_b32 v71, 16, v32
    v_and_b32 v72, 0xffff0000, v32
    v_fmac_f32 v8, v71, v64
    v_fmac_f32 v9, v72, v64
    v_lshlrev_b32 v71, 16, v33
    v_and_b32 v72, 0xffff0000, v33
    v_fmac_f32 v10, v71, v64
    v_fmac_f32 v11, v72, v64
    v_lshlrev_b32 v71, 16, v34
    v_and_b32 v72, 0xffff0000, v34
    v_fmac_f32 v12, v71, v64
    v_fmac_f32 v13, v72, v64
    v_lshlrev_b32 v71, 16, v35
    v_and_b32 v72, 0xffff0000, v35
    v_fmac_f32 v14, v71, v64
    v_fmac_f32 v15, v72, v64
    s_waitcnt vmcnt(2)
    v_lshlrev_b32 v71, 16, v36
    v_and_b32 v72, 0xffff0000, v36
    v_fmac_f32 v8, v71, v65
    v_fmac_f32 v9, v72, v65
    v_lshlrev_b32 v71, 16, v37
    v_and_b32 v72, 0xffff0000, v37
    v_fmac_f32 v10, v71, v65
    v_fmac_f32 v11, v72, v65
    v_lshlrev_b32 v71, 16, v38
    v_and_b32 v72, 0xffff0000, v38
    v_fmac_f32 v12, v71, v65
    v_fmac_f32 v13, v72, v65
    v_lshlrev_b32 v71, 16, v39
    v_and_b32 v72, 0xffff0000, v39
    v_fmac_f32 v14, v71, v65
    v_fmac_f32 v15, v72, v65
    s_waitcnt vmcnt(1)
    v_lshlrev_b32 v71, 16, v40
    v_and_b32 v72, 0xffff0000, v40
    v_fmac_f32 v8, v71, v66
    v_fmac_f32 v9, v72, v66
    v_lshlrev_b32 v71, 16, v41
    v_and_b32 v72, 0xffff0000, v41
    v_fmac_f32 v10, v71, v66
    v_fmac_f32 v11, v72, v66
    v_lshlrev_b32 v71, 16, v42
    v_and_b32 v72, 0xffff0000, v42
    v_fmac_f32 v12, v71, v66
    v_fmac_f32 v13, v72, v66
    v_lshlrev_b32 v71, 16, v43
    v_and_b32 v72, 0xffff0000, v43
    v_fmac_f32 v14, v71, v66
    v_fmac_f32 v15, v72, v66
    s_waitcnt vmcnt(0)
    v_lshlrev_b32 v71, 16, v44
    v_and_b32 v72, 0xffff0000, v44
    v_fmac_f32 v8, v71, v67
    v_fmac_f32 v9, v72, v67
    v_lshlrev_b32 v71, 16, v45
    v_and_b32 v72, 0xffff0000, v45
    v_fmac_f32 v10, v71, v67
    v_fmac_f32 v11, v72, v67
    v_lshlrev_b32 v71, 16, v46
    v_and_b32 v72, 0xffff0000, v46
    v_fmac_f32 v12, v71, v67
    v_fmac_f32 v13, v72, v67
    v_lshlrev_b32 v71, 16, v47
    v_and_b32 v72, 0xffff0000, v47
    v_fmac_f32 v14, v71, v67
    v_fmac_f32 v15, v72, v67
    v_lshlrev_b32 v6, 8, v2
    v_lshlrev_b32 v7, 5, v1
    v_add_u32 v6, v6, v7
    ds_write_b128 v6, v[8:11]
    ds_write_b128 v6, v[12:15] offset:16
    s_waitcnt lgkmcnt(0)
    s_barrier
    v_cmp_gt_u32 vcc, 64, v0
    s_and_saveexec_b64 s[26:27], vcc
    s_cbranch_execz L_o_done
    v_lshlrev_b32 v6, 2, v0
    ds_read_b32 v16, v6 offset:0
    ds_read_b32 v17, v6 offset:256
    ds_read_b32 v18, v6 offset:512
    ds_read_b32 v19, v6 offset:768
    ds_read_b32 v20, v6 offset:1024
    ds_read_b32 v21, v6 offset:1280
    ds_read_b32 v22, v6 offset:1536
    ds_read_b32 v23, v6 offset:1792
    ds_read_b32 v24, v6 offset:2048
    ds_read_b32 v25, v6 offset:2304
    ds_read_b32 v26, v6 offset:2560
    ds_read_b32 v27, v6 offset:2816
    ds_read_b32 v28, v6 offset:3072
    ds_read_b32 v29, v6 offset:3328
    ds_read_b32 v30, v6 offset:3584
    ds_read_b32 v31, v6 offset:3840
    ds_read_b32 v32, v6 offset:4096
    ds_read_b32 v33, v6 offset:4352
    ds_read_b32 v34, v6 offset:4608
    ds_read_b32 v35, v6 offset:4864
    ds_read_b32 v36, v6 offset:5120
    ds_read_b32 v37, v6 offset:5376
    ds_read_b32 v38, v6 offset:5632
    ds_read_b32 v39, v6 offset:5888
    ds_read_b32 v40, v6 offset:6144
    ds_read_b32 v41, v6 offset:6400
    ds_read_b32 v42, v6 offset:6656
    ds_read_b32 v43, v6 offset:6912
    ds_read_b32 v44, v6 offset:7168
    ds_read_b32 v45, v6 offset:7424
    ds_read_b32 v46, v6 offset:7680
    ds_read_b32 v47, v6 offset:7936
    s_waitcnt lgkmcnt(0)
    v_add_f32 v16, v16, v17
    v_add_f32 v16, v16, v18
    v_add_f32 v16, v16, v19
    v_add_f32 v16, v16, v20
    v_add_f32 v16, v16, v21
    v_add_f32 v16, v16, v22
    v_add_f32 v16, v16, v23
    v_add_f32 v16, v16, v24
    v_add_f32 v16, v16, v25
    v_add_f32 v16, v16, v26
    v_add_f32 v16, v16, v27
    v_add_f32 v16, v16, v28
    v_add_f32 v16, v16, v29
    v_add_f32 v16, v16, v30
    v_add_f32 v16, v16, v31
    v_add_f32 v16, v16, v32
    v_add_f32 v16, v16, v33
    v_add_f32 v16, v16, v34
    v_add_f32 v16, v16, v35
    v_add_f32 v16, v16, v36
    v_add_f32 v16, v16, v37
    v_add_f32 v16, v16, v38
    v_add_f32 v16, v16, v39
    v_add_f32 v16, v16, v40
    v_add_f32 v16, v16, v41
    v_add_f32 v16, v16, v42
    v_add_f32 v16, v16, v43
    v_add_f32 v16, v16, v44
    v_add_f32 v16, v16, v45
    v_add_f32 v16, v16, v46
    v_add_f32 v16, v16, v47
    s_mul_i32 s24, s3, 10
    s_add_u32 s24, s24, s22
    s_lshl_b32 s25, s24, 12
    s_add_u32 s25, s25, 737280
    s_lshl_b32 s28, s21, 8
    s_add_u32 s28, s28, s25
    buffer_store_dword v16, v6, s[16:19], s28 offen sc1
    s_waitcnt vmcnt(0)
    v_mov_b32 v8, 1
    s_lshl_b32 s29, s24, 2
    v_mov_b32 v9, s29
    v_cmp_eq_u32 vcc, 0, v0
    s_and_saveexec_b64 s[30:31], vcc
    buffer_atomic_add v8, v9, s[40:43], 0 offen sc0
    s_waitcnt vmcnt(0)
    s_mov_b64 exec, s[30:31]
    v_readfirstlane_b32 s29, v8
    s_cmp_lg_u32 s29, 15
    s_cbranch_scc1 L_o_done
    buffer_load_dword v16, v6, s[16:19], s25 offen offset:0 sc1
    buffer_load_dword v17, v6, s[16:19], s25 offen offset:256 sc1
    buffer_load_dword v18, v6, s[16:19], s25 offen offset:512 sc1
    buffer_load_dword v19, v6, s[16:19], s25 offen offset:768 sc1
    buffer_load_dword v20, v6, s[16:19], s25 offen offset:1024 sc1
    buffer_load_dword v21, v6, s[16:19], s25 offen offset:1280 sc1
    buffer_load_dword v22, v6, s[16:19], s25 offen offset:1536 sc1
    buffer_load_dword v23, v6, s[16:19], s25 offen offset:1792 sc1
    buffer_load_dword v24, v6, s[16:19], s25 offen offset:2048 sc1
    buffer_load_dword v25, v6, s[16:19], s25 offen offset:2304 sc1
    buffer_load_dword v26, v6, s[16:19], s25 offen offset:2560 sc1
    buffer_load_dword v27, v6, s[16:19], s25 offen offset:2816 sc1
    buffer_load_dword v28, v6, s[16:19], s25 offen offset:3072 sc1
    buffer_load_dword v29, v6, s[16:19], s25 offen offset:3328 sc1
    buffer_load_dword v30, v6, s[16:19], s25 offen offset:3584 sc1
    buffer_load_dword v31, v6, s[16:19], s25 offen offset:3840 sc1
    s_waitcnt vmcnt(0)
    v_add_f32 v16, v16, v17
    v_add_f32 v16, v16, v18
    v_add_f32 v16, v16, v19
    v_add_f32 v16, v16, v20
    v_add_f32 v16, v16, v21
    v_add_f32 v16, v16, v22
    v_add_f32 v16, v16, v23
    v_add_f32 v16, v16, v24
    v_add_f32 v16, v16, v25
    v_add_f32 v16, v16, v26
    v_add_f32 v16, v16, v27
    v_add_f32 v16, v16, v28
    v_add_f32 v16, v16, v29
    v_add_f32 v16, v16, v30
    v_add_f32 v16, v16, v31
    v_cvt_pk_bf16_f32 v16, v16, v16
    s_mul_i32 s24, s3, 1280
    s_lshl_b32 s28, s22, 7
    s_add_u32 s24, s24, s28
    v_lshlrev_b32 v7, 1, v0
    buffer_store_short v16, v7, s[12:15], s24 offen
L_o_done:
    s_endpgm
.section .rodata,"a"
.p2align 6
.amdhsa_kernel qproj_kernel
  .amdhsa_next_free_vgpr 80
  .amdhsa_next_free_sgpr 64
  .amdhsa_accum_offset 80
  .amdhsa_group_segment_fixed_size 0
  .amdhsa_kernarg_size 104
  .amdhsa_user_sgpr_count 2
  .amdhsa_user_sgpr_kernarg_segment_ptr 1
  .amdhsa_system_sgpr_workgroup_id_x 1
.end_amdhsa_kernel
.p2align 6
.amdhsa_kernel attn_kernel
  .amdhsa_next_free_vgpr 160
  .amdhsa_next_free_sgpr 64
  .amdhsa_accum_offset 160
  .amdhsa_group_segment_fixed_size 0
  .amdhsa_kernarg_size 104
  .amdhsa_user_sgpr_count 2
  .amdhsa_user_sgpr_kernarg_segment_ptr 1
  .amdhsa_system_sgpr_workgroup_id_x 1
.end_amdhsa_kernel
.p2align 6
.amdhsa_kernel oproj_kernel
  .amdhsa_next_free_vgpr 112
  .amdhsa_next_free_sgpr 64
  .amdhsa_accum_offset 112
  .amdhsa_group_segment_fixed_size 0
  .amdhsa_kernarg_size 104
  .amdhsa_user_sgpr_count 2
  .amdhsa_user_sgpr_kernarg_segment_ptr 1
  .amdhsa_system_sgpr_workgroup_id_x 1
.end_amdhsa_kernel
```
